```python
import torch

def _softmax(x, axis=-1):
    return torch.softmax(x, dim=axis)

def _gelu(x):
    return torch.nn.functional.gelu(x, approximate='tanh')

def _silu(x):
    return torch.nn.functional.silu(x)

def _sigmoid(x):
    return torch.sigmoid(x)

def _layernorm(x, axis=-1, eps=1e-05):
    m = x.mean(dim=axis, keepdim=True)
    v = x.var(dim=axis, keepdim=True, unbiased=False)
    return (x - m) / torch.sqrt(v + eps)

def _scatter_add(tgt, idx, src, axis=0):
    return tgt.clone().index_add_(axis, idx, src)

def _segment_sum(src, seg, n):
    out = torch.zeros((n,) + src.shape[1:], dtype=src.dtype)
    return out.index_add_(0, seg, src)

def _pad(x, pw):
    flat = tuple((v for pair in reversed(pw) for v in pair))
    return torch.nn.functional.pad(x, flat)
kernel_name = 'gather_scatter__molecular_angular_painn__graph'

def setup_inputs():

    _w = lambda a: (lambda t: t.to(torch.bfloat16) if t.is_floating_point() else t)(torch.as_tensor(a))
    N, deg, D = (25000, 32, 64)
    n_rbf = max(0, 4)
    E = N * deg
    cutoff = 5.0
    freqs = (torch.arange(1, n_rbf + 1) * torch.pi / cutoff).to(float)
    return {'sv': _w((lambda *s: torch.randn(*s, dtype=torch.bfloat16) * 0.4)(N, 4, D) * 0.3), 'pos': _w((lambda *s: torch.randn(*s, dtype=torch.bfloat16) * 3.2)(N, 3) * 1.2), 'src': _w((lambda lo, hi, *s: torch.randint(lo, hi, s))(0, N, E).to(torch.int64)), 'dst': _w((lambda lo, hi, *s: torch.randint(lo, hi, s))(0, N, E).to(torch.int64)), 'freqs': _w(freqs), 'w_phi1': _w((lambda *s: torch.randn(*s, dtype=torch.bfloat16) * 3.2)(D, D) / D ** 0.5), 'w_phi2': _w((lambda *s: torch.randn(*s, dtype=torch.bfloat16) * 3.2)(D, 3 * D) / D ** 0.5), 'w_rbf': _w((lambda *s: torch.randn(*s, dtype=torch.bfloat16) * 3.2)(n_rbf, 3 * D) / n_rbf ** 0.5)}

def reference(sv, pos, src, dst, freqs, w_phi1, w_phi2, w_rbf):
    N, _, D = sv.shape
    E = src.shape[0]
    PI, cutoff = (3.141592653589793, 5.0)
    s, v = (sv[:, 0, :].clone(), sv[:, 1:, :].clone())
    r_vec = pos[src] - pos[dst]
    d = torch.sqrt((r_vec * r_vec).sum(-1) + 1e-08)
    r_hat = r_vec / d[:, None]
    rbf = torch.sin(d[:, None] * freqs[None, :]) / d[:, None]
    fcut = 0.5 * (torch.cos(PI * d / cutoff) + 1.0)
    fcut = torch.where(d < cutoff, fcut, 0.0 * d)
    Wf = rbf @ w_rbf * fcut[:, None]
    phi = (_silu(s @ w_phi1) @ w_phi2)[src]
    m = phi * Wf
    m_s, m_vv, m_vr = (m[:, :D].clone(), m[:, D:2 * D].clone(), m[:, 2 * D:].clone())
    ds = _segment_sum(m_s, dst, N)
    dv_e = m_vv[:, None, :] * v[src] + m_vr[:, None, :] * r_hat[:, :, None]
    dv = _segment_sum(dv_e.reshape(E, 3 * D), dst, N).reshape(N, 3, D)
    return sv + torch.concatenate([ds[:, None, :], dv], axis=1)
```

```asm
; @launch grid=(256,1,1) block=(512,1,1) lds=163840
.amdgcn_target "amdgcn-amd-amdhsa--gfx950"
.text
.globl gather_scatter__molecular_angular_painn__graph_kernel
.p2align 8
.type gather_scatter__molecular_angular_painn__graph_kernel,@function
gather_scatter__molecular_angular_painn__graph_kernel:
    s_load_dwordx4 s[4:7], s[0:1], 0
    s_load_dwordx4 s[56:59], s[0:1], 16
    s_load_dwordx4 s[60:63], s[0:1], 32
    s_load_dwordx2 s[46:47], s[0:1], 80
    s_load_dwordx4 s[76:79], s[0:1], 48
    s_load_dwordx2 s[44:45], s[0:1], 64
    s_cmp_ge_u32 s2, 256
    s_cbranch_scc1 L_end
    v_lshrrev_b32 v1, 6, v0
    v_and_b32 v249, 63, v0
    v_readfirstlane_b32 s3, v1
    v_mov_b32 v228, v0
    s_cmp_lg_u32 s3, 0
    s_cbranch_scc1 L_nocpf
    s_getpc_b64 s[8:9]
    s_lshr_b32 s10, s2, 3
    s_mul_i32 s10, s10, 5
    v_add_u32 v2, s10, v249
    v_min_u32 v2, 140, v2
    v_lshlrev_b32 v2, 7, v2
    v_mov_b32 v3, s9
    v_add_co_u32 v2, vcc, s8, v2
    s_mov_b64 exec, 31
    s_nop 0
    v_addc_co_u32 v3, vcc, 0, v3, vcc
    global_load_dword v253, v[2:3], off
    s_mov_b64 exec, -1
L_nocpf:
    s_and_b32 s28, s2, 7
    s_mul_i32 s31, s2, 6
    s_lshl_b32 s28, s28, 5
    s_lshr_b32 s36, s2, 3
    s_lshl_b32 s34, s3, 14
    s_add_u32 s31, s31, s3
    s_add_u32 s28, s28, s36
    s_add_u32 s34, s34, 32768
    s_lshl_b32 s30, s3, 10
    s_sub_u32 s31, s31, 1
    s_add_u32 s32, s2, 1536
    s_cmp_eq_u32 s3, 7
    s_cselect_b32 s31, s32, s31
    s_cmp_eq_u32 s3, 0
    s_mul_i32 s37, s36, 5
    s_cselect_b32 s31, 1563, s31
    s_add_u32 s37, s37, s3
    s_min_u32 s31, s31, 1563
    s_mul_i32 s33, s2, 12512
    s_lshl_b32 s37, s37, 10
    s_lshl_b32 s32, s31, 13
    s_add_u32 s39, s33, 8192
    s_add_u32 s35, s33, 12288
    s_sub_u32 s38, s37, 150528
    s_cselect_b32 s37, s37, s38
    s_add_u32 s52, s37, 131072
    v_lshrrev_b32 v125, 4, v249
    s_sub_u32 s38, s52, 150528
    v_lshlrev_b32 v126, 1, v125
    v_and_b32 v130, 7, v249
    s_cselect_b32 s52, s52, s38
    v_xor_b32 v126, v126, v130
    s_add_u32 s53, s52, 8192
    v_lshrrev_b32 v124, 3, v249
    v_lshlrev_b32 v126, 4, v126
    v_lshlrev_b32 v129, 2, v0
    v_cmp_gt_u32 vcc, 56, v0
    s_sub_u32 s38, s53, 150528
    s_mul_i32 s29, s28, 98
    v_lshlrev_b32 v231, 4, v249
    v_lshl_add_u32 v126, v124, 9, v126
    v_lshlrev_b32 v232, 4, v0
    v_lshlrev_b32 v128, 3, v0
    v_cndmask_b32 v129, 2.0, v129, vcc
    s_cselect_b32 s53, s53, s38
    s_waitcnt lgkmcnt(0)
    s_mov_b32 s20, s62
    s_mov_b32 s21, s63
    s_mov_b32 s22, 8192
    s_mov_b32 s23, 0x00020000
    s_add_u32 m0, s30, 151072
    s_mov_b32 s8, s4
    buffer_load_dwordx4 v231, s[20:23], s30 offen lds
    s_mov_b32 s9, s5
    s_mov_b32 s10, 12800000
    s_mov_b32 s11, 0x00020000
    s_mov_b32 m0, s52
    s_mov_b32 s16, s46
    s_mov_b32 s17, s47
    s_mov_b32 s18, 11534336
    s_mov_b32 s19, 0x00020000
    s_mov_b32 s48, s56
    s_mov_b32 s49, s57
    s_mov_b32 s50, 3200000
    s_mov_b32 s51, 0x00020000
    s_mov_b32 s72, s58
    s_mov_b32 s73, s59
    s_mov_b32 s74, 3200000
    s_mov_b32 s75, 0x00020000
    buffer_load_dwordx4 v126, s[8:11], s32 offen lds
    s_add_u32 s32, s32, 4096
    s_mov_b32 m0, s53
    s_cmp_lg_u32 s3, 0
    buffer_load_dwordx4 v126, s[8:11], s32 offen lds
    s_load_dwordx2 s[40:41], s[60:61], 0
    s_mov_b32 s38, 11468800
    s_load_dword s42, s[46:47], s38
    s_barrier
    s_cbranch_scc1 L_noidx6
    buffer_load_dword v218, v129, s[48:51], s35 offen
    buffer_load_dword v226, v129, s[72:75], s35 offen
L_noidx6:
    s_mov_b32 s24, s6
    s_mov_b32 s25, s7
    s_mov_b32 s26, 150000
    s_mov_b32 s27, 0x00020000
    s_mov_b32 m0, s37
    v_and_b32 v124, 15, v249
    buffer_load_dwordx4 v231, s[24:27], s37 offen lds
    s_add_u32 s37, s37, 8192
    s_sub_u32 s38, s37, 150528
    s_cselect_b32 s37, s37, s38
    s_mov_b32 m0, s37
    v_lshrrev_b32 v130, 2, v124
    v_mov_b32 v126, s52
    v_mov_b32 v127, s53
    v_cmp_gt_u32 vcc, 8, v124
    v_lshl_add_u32 v130, v125, 3, v130
    v_and_b32 v131, 3, v249
    v_cndmask_b32 v126, v127, v126, vcc
    v_lshlrev_b32 v130, 7, v130
    v_and_b32 v127, 7, v124
    v_lshl_add_u32 v130, v131, 4, v130
    v_lshl_add_u32 v126, v127, 7, v126
    v_min_u32 v131, 0x83, v228
    v_and_b32 v127, 6, v124
    v_lshlrev_b32 v131, 2, v131
    v_xor_b32 v127, v127, v125
    buffer_load_dwordx4 v231, s[24:27], s37 offen lds
    s_add_u32 s37, s37, 8192
    s_sub_u32 s38, s37, 150528
    s_cselect_b32 s37, s37, s38
    s_mov_b32 m0, s37
    v_add_u32 v131, 150528, v131
    v_mov_b32 v229, 0
    v_lshl_add_u32 v126, v127, 4, v126
    v_add_u32 v130, 151072, v130
    ds_write_b32 v131, v229
    v_xor_b32 v127, 64, v126
    buffer_load_dwordx4 v231, s[24:27], s37 offen lds
    s_add_u32 s37, s37, 8192
    s_sub_u32 s38, s37, 150528
    s_cselect_b32 s37, s37, s38
    s_mov_b32 m0, s37
    s_nop 0
    buffer_load_dwordx4 v231, s[24:27], s37 offen lds
    s_add_u32 s37, s37, 8192
    s_sub_u32 s38, s37, 150528
    s_cselect_b32 s37, s37, s38
    s_mov_b32 m0, s37
    s_nop 0
    buffer_load_dwordx4 v231, s[24:27], s37 offen lds
    s_add_u32 s37, s37, 8192
    s_sub_u32 s38, s37, 150528
    s_cselect_b32 s37, s37, s38
    s_mov_b32 m0, s37
    s_nop 0
    buffer_load_dwordx4 v231, s[24:27], s37 offen lds
    s_add_u32 s37, s37, 8192
    s_sub_u32 s38, s37, 150528
    s_cselect_b32 s37, s37, s38
    s_waitcnt vmcnt(6) lgkmcnt(0)
    s_barrier
    s_mov_b32 m0, s37
    ds_read_b128 v[164:167], v126
    ds_read_b128 v[168:171], v127
    ds_read_b64_tr_b16 v[132:133], v130 offset:0
    ds_read_b64_tr_b16 v[134:135], v130 offset:512
    ds_read_b64_tr_b16 v[136:137], v130 offset:4096
    ds_read_b64_tr_b16 v[138:139], v130 offset:4608
    ds_read_b64_tr_b16 v[140:141], v130 offset:8
    ds_read_b64_tr_b16 v[142:143], v130 offset:520
    buffer_load_dwordx4 v231, s[24:27], s37 offen lds
    s_add_u32 s37, s37, 8192
    s_sub_u32 s38, s37, 150528
    s_cselect_b32 s37, s37, s38
    s_mov_b32 m0, s37
    ds_read_b64_tr_b16 v[144:145], v130 offset:4104
    buffer_load_dwordx4 v[212:215], v232, s[48:51], s33 offen
    ds_read_b64_tr_b16 v[146:147], v130 offset:4616
    ds_read_b64_tr_b16 v[148:149], v130 offset:64
    ds_read_b64_tr_b16 v[150:151], v130 offset:576
    ds_read_b64_tr_b16 v[152:153], v130 offset:4160
    ds_read_b64_tr_b16 v[154:155], v130 offset:4672
    ds_read_b64_tr_b16 v[156:157], v130 offset:72
    ds_read_b64_tr_b16 v[158:159], v130 offset:584
    buffer_load_dwordx4 v231, s[24:27], s37 offen lds
    s_add_u32 s37, s37, 8192
    s_sub_u32 s38, s37, 150528
    s_cselect_b32 s37, s37, s38
    s_mov_b32 m0, s37
    ds_read_b64_tr_b16 v[160:161], v130 offset:4168
    ds_read_b64_tr_b16 v[162:163], v130 offset:4680
    buffer_load_dwordx4 v[220:223], v232, s[72:75], s33 offen
    buffer_load_dwordx4 v231, s[24:27], s37 offen lds
    s_add_u32 s37, s37, 8192
    s_sub_u32 s38, s37, 150528
    s_cselect_b32 s37, s37, s38
    s_mov_b32 m0, s37
    buffer_load_dwordx2 v[216:217], v128, s[48:51], s39 offen
    buffer_load_dwordx4 v231, s[24:27], s37 offen lds
    s_add_u32 s37, s37, 8192
    s_sub_u32 s38, s37, 150528
    s_cselect_b32 s37, s37, s38
    s_mov_b32 m0, s37
    buffer_load_dwordx2 v[224:225], v128, s[72:75], s39 offen
    buffer_load_dwordx4 v231, s[24:27], s37 offen lds
    s_add_u32 s37, s37, 8192
    s_sub_u32 s38, s37, 150528
    s_cselect_b32 s37, s37, s38
    s_mov_b32 m0, s37
    s_nop 0
    buffer_load_dwordx4 v231, s[24:27], s37 offen lds
    s_add_u32 s37, s37, 8192
    s_sub_u32 s38, s37, 150528
    s_cselect_b32 s37, s37, s38
    s_mov_b32 m0, s37
    s_nop 0
    buffer_load_dwordx4 v231, s[24:27], s37 offen lds
    s_add_u32 s37, s37, 8192
    s_sub_u32 s38, s37, 150528
    s_cselect_b32 s37, s37, s38
    s_mov_b32 m0, s37
    s_nop 0
    buffer_load_dwordx4 v231, s[24:27], s37 offen lds
    s_add_u32 s37, s37, 8192
    s_sub_u32 s38, s37, 150528
    s_cselect_b32 s37, s37, s38
    s_mov_b32 m0, s37
    s_nop 0
    buffer_load_dwordx4 v231, s[24:27], s37 offen lds
    s_add_u32 s37, s37, 8192
    s_sub_u32 s38, s37, 150528
    s_cselect_b32 s37, s37, s38
    s_mov_b32 m0, s37
    s_nop 0
    buffer_load_dwordx4 v231, s[24:27], s37 offen lds
    s_add_u32 s37, s37, 8192
    s_sub_u32 s38, s37, 150528
    s_cselect_b32 s37, s37, s38
    s_add_u32 s80, s46, 7340032
    s_addc_u32 s81, s47, 0
    s_mov_b32 s12, s80
    s_mov_b32 s13, s81
    s_mov_b32 s14, 3200000
    s_mov_b32 s15, 0x00020000
    s_lshl_b32 s80, s31, 11
    s_mov_b32 s30, 0xbfb8aa3b
    s_cmp_gt_u32 s3, 2
    s_cbranch_scc1 L_no19
    s_add_u32 s38, s37, 16384
    s_sub_u32 s81, s38, 150528
    s_cselect_b32 s38, s38, s81
    s_mov_b32 m0, s38
    s_nop 0
    buffer_load_dwordx4 v231, s[24:27], s38 offen lds
L_no19:
    s_mov_b32 s81, s31
    s_cmp_eq_u32 s31, 1563
    s_waitcnt lgkmcnt(0)
    s_cbranch_scc1 L_notile
    v_mfma_f32_16x16x32_bf16 v[172:175], v[132:135], v[164:167], 0
    v_add_u32 v130, s52, v231
    v_add_u32 v131, s53, v231
    v_mfma_f32_16x16x32_bf16 v[176:179], v[140:143], v[164:167], 0
    v_lshrrev_b32 v124, 3, v249
    v_mfma_f32_16x16x32_bf16 v[180:183], v[148:151], v[164:167], 0
    v_mfma_f32_16x16x32_bf16 v[184:187], v[156:159], v[164:167], 0
    v_mfma_f32_16x16x32_bf16 v[172:175], v[136:139], v[168:171], v[172:175]
    v_mfma_f32_16x16x32_bf16 v[176:179], v[144:147], v[168:171], v[176:179]
    v_mfma_f32_16x16x32_bf16 v[180:183], v[152:155], v[168:171], v[180:183]
    v_mfma_f32_16x16x32_bf16 v[184:187], v[160:163], v[168:171], v[184:187]
    s_nop 4
    v_cvt_pk_bf16_f32 v173, v172, v173
    v_cvt_pk_bf16_f32 v175, v174, v175
    v_cvt_pk_bf16_f32 v177, v176, v177
    v_cvt_pk_bf16_f32 v179, v178, v179
    v_cvt_pk_bf16_f32 v181, v180, v181
    v_cvt_pk_bf16_f32 v183, v182, v183
    v_cvt_pk_bf16_f32 v185, v184, v185
    v_cvt_pk_bf16_f32 v187, v186, v187
    v_lshlrev_b32 v172, 16, v173
    v_lshlrev_b32 v174, 16, v175
    v_lshlrev_b32 v176, 16, v177
    v_lshlrev_b32 v178, 16, v179
    v_and_b32 v173, 0xffff0000, v173
    v_and_b32 v175, 0xffff0000, v175
    v_and_b32 v177, 0xffff0000, v177
    v_and_b32 v179, 0xffff0000, v179
    v_lshlrev_b32 v180, 16, v181
    v_lshlrev_b32 v182, 16, v183
    v_lshlrev_b32 v184, 16, v185
    v_lshlrev_b32 v186, 16, v187
    v_and_b32 v181, 0xffff0000, v181
    v_and_b32 v183, 0xffff0000, v183
    v_and_b32 v185, 0xffff0000, v185
    v_and_b32 v187, 0xffff0000, v187
    v_mul_f32 v188, s30, v172
    v_mul_f32 v189, s30, v173
    v_mul_f32 v190, s30, v174
    v_mul_f32 v191, s30, v175
    v_mul_f32 v192, s30, v176
    v_mul_f32 v193, s30, v177
    v_mul_f32 v194, s30, v178
    v_mul_f32 v195, s30, v179
    v_mul_f32 v196, s30, v180
    v_mul_f32 v197, s30, v181
    v_mul_f32 v198, s30, v182
    v_mul_f32 v199, s30, v183
    v_mul_f32 v200, s30, v184
    v_mul_f32 v201, s30, v185
    v_mul_f32 v202, s30, v186
    v_mul_f32 v203, s30, v187
    v_exp_f32 v188, v188
    v_exp_f32 v189, v189
    v_exp_f32 v190, v190
    v_exp_f32 v191, v191
    v_exp_f32 v192, v192
    v_exp_f32 v193, v193
    v_exp_f32 v194, v194
    v_exp_f32 v195, v195
    v_exp_f32 v196, v196
    v_exp_f32 v197, v197
    v_exp_f32 v198, v198
    v_exp_f32 v199, v199
    v_exp_f32 v200, v200
    v_exp_f32 v201, v201
    v_exp_f32 v202, v202
    v_exp_f32 v203, v203
    v_add_f32 v188, 1.0, v188
    v_add_f32 v189, 1.0, v189
    v_add_f32 v190, 1.0, v190
    v_add_f32 v191, 1.0, v191
    v_add_f32 v192, 1.0, v192
    v_add_f32 v193, 1.0, v193
    v_add_f32 v194, 1.0, v194
    v_add_f32 v195, 1.0, v195
    v_add_f32 v196, 1.0, v196
    v_add_f32 v197, 1.0, v197
    v_add_f32 v198, 1.0, v198
    v_add_f32 v199, 1.0, v199
    v_add_f32 v200, 1.0, v200
    v_add_f32 v201, 1.0, v201
    v_add_f32 v202, 1.0, v202
    v_add_f32 v203, 1.0, v203
    v_rcp_f32 v188, v188
    v_rcp_f32 v189, v189
    v_rcp_f32 v190, v190
    v_rcp_f32 v191, v191
    v_rcp_f32 v192, v192
    v_rcp_f32 v193, v193
    v_rcp_f32 v194, v194
    v_rcp_f32 v195, v195
    v_rcp_f32 v196, v196
    v_rcp_f32 v197, v197
    v_rcp_f32 v198, v198
    v_rcp_f32 v199, v199
    v_rcp_f32 v200, v200
    v_rcp_f32 v201, v201
    v_rcp_f32 v202, v202
    v_rcp_f32 v203, v203
    v_mul_f32 v188, v188, v172
    v_mul_f32 v189, v189, v173
    v_mul_f32 v190, v190, v174
    v_mul_f32 v191, v191, v175
    v_mul_f32 v192, v192, v176
    v_mul_f32 v193, v193, v177
    v_mul_f32 v194, v194, v178
    v_mul_f32 v195, v195, v179
    v_mul_f32 v196, v196, v180
    v_mul_f32 v197, v197, v181
    v_mul_f32 v198, v198, v182
    v_mul_f32 v199, v199, v183
    v_mul_f32 v200, v200, v184
    v_mul_f32 v201, v201, v185
    v_mul_f32 v202, v202, v186
    v_mul_f32 v203, v203, v187
    v_cvt_pk_bf16_f32 v204, v188, v189
    v_cvt_pk_bf16_f32 v205, v190, v191
    v_cvt_pk_bf16_f32 v206, v192, v193
    v_cvt_pk_bf16_f32 v207, v194, v195
    v_cvt_pk_bf16_f32 v208, v196, v197
    v_cvt_pk_bf16_f32 v209, v198, v199
    v_cvt_pk_bf16_f32 v210, v200, v201
    v_cvt_pk_bf16_f32 v211, v202, v203
    ds_write_b128 v126, v[204:207]
    ds_write_b128 v127, v[208:211]
    v_lshlrev_b32 v126, 1, v125
    ds_read_b128 v[172:175], v130
    ds_read_b128 v[176:179], v131
    v_and_b32 v127, 7, v249
    v_xor_b32 v126, v126, v127
    v_lshlrev_b32 v126, 4, v126
    v_lshl_add_u32 v126, v124, 7, v126
    s_waitcnt lgkmcnt(0)
L_notile:
    s_mov_b32 m0, s37
    s_nop 0
    buffer_load_dwordx4 v231, s[24:27], s37 offen lds
    s_add_u32 s37, s37, 8192
    s_sub_u32 s38, s37, 150528
    s_cselect_b32 s37, s37, s38
    s_mov_b32 m0, s37
    s_nop 0
    buffer_load_dwordx4 v231, s[24:27], s37 offen lds
    s_add_u32 s37, s37, 8192
    s_sub_u32 s38, s37, 150528
    s_cselect_b32 s37, s37, s38
    s_cmp_eq_u32 s81, 1563
    s_cbranch_scc1 L_nohst
    buffer_store_dwordx4 v[172:175], v126, s[12:15], s80 offen sc1
    buffer_store_dwordx4 v[176:179], v126, s[12:15], s80 offen offset:1024 sc1
L_nohst:
    s_waitcnt vmcnt(8)
    s_mul_i32 s37, s2, 3128
    s_sub_u32 s37, 800000, s37
    s_sub_u32 s38, s37, 2048
    s_mul_i32 s42, s42, 0x9e3779b1
    s_lshr_b32 s38, s38, 1
    s_add_u32 s42, s42, 0x7f4a7c15
    v_cmp_gt_u32 s[70:71], s38, v228
    s_sub_u32 s37, s37, 3072
    s_lshl_b32 s88, s42, 27
    s_lshr_b32 s38, s42, 5
    s_max_i32 s37, s37, 0
    s_lshl_b32 s86, s42, 9
    s_lshl_b32 s87, s42, 18
    s_or_b32 s88, s88, s38
    s_min_u32 s37, s37, 56
    s_and_b32 s85, s42, 0xff800000
    s_and_b32 s86, s86, 0xff800000
    s_and_b32 s87, s87, 0xff800000
    s_and_b32 s88, s88, 0xff800000
    v_and_b32 v233, 31, v249
    s_cmp_eq_u32 s3, 0
    v_cmp_gt_u32 s[52:53], s37, v228
    v_lshrrev_b32 v124, 5, v249
    v_lshlrev_b32 v233, 4, v233
    s_cselect_b32 s37, 32, 0
    v_lshl_add_u32 v233, v124, 13, v233
    v_cmp_gt_u32 vcc, s37, v249
    v_subrev_u32 v236, 24, v249
    v_mul_u32_u24 v64, 5350, v220
    v_cndmask_b32 v234, 2.0, v233, vcc
    v_mul_u32_u24 v65, 5350, v221
    v_mul_u32_u24 v66, 5350, v222
    v_mul_u32_u24 v67, 5350, v223
    v_mul_u32_u24 v68, 5350, v224
    v_mul_u32_u24 v69, 5350, v225
    s_and_b32 s49, s3, 3
    v_min_u32 v236, v236, v249
    v_cmp_lt_u32 vcc, 23, v249
    s_lshl_b32 s82, s3, 1
    s_movk_i32 s30, -98
    v_lshrrev_b32 v64, 19, v64
    v_lshrrev_b32 v65, 19, v65
    v_lshrrev_b32 v66, 19, v66
    v_lshrrev_b32 v67, 19, v67
    v_lshrrev_b32 v68, 19, v68
    v_lshrrev_b32 v69, 19, v69
    s_mul_i32 s83, s49, 6144
    v_lshlrev_b32 v236, 4, v236
    v_cndmask_b32 v240, 0, 1, vcc
    s_add_u32 s82, s82, s29
    s_lshl_b32 s49, s49, 14
    s_mov_b32 s31, 150016
    s_mov_b32 s32, 151076
    v_mul_u32_u24 v32, 6, v212
    v_mul_u32_u24 v40, 6, v220
    v_mad_i32_i24 v72, v64, s30, v220
    v_mul_u32_u24 v33, 6, v213
    v_mul_u32_u24 v41, 6, v221
    v_mad_i32_i24 v73, v65, s30, v221
    v_mul_u32_u24 v34, 6, v214
    v_mul_u32_u24 v42, 6, v222
    v_mad_i32_i24 v74, v66, s30, v222
    v_mul_u32_u24 v35, 6, v215
    v_mul_u32_u24 v43, 6, v223
    v_mad_i32_i24 v75, v67, s30, v223
    v_mul_u32_u24 v36, 6, v216
    v_mul_u32_u24 v44, 6, v224
    v_mad_i32_i24 v76, v68, s30, v224
    v_mul_u32_u24 v37, 6, v217
    v_mul_u32_u24 v45, 6, v225
    v_mad_i32_i24 v77, v69, s30, v225
    v_mul_u32_u24 v240, 384, v240
    v_xor_b32 v237, 32, v236
    v_xor_b32 v238, 64, v236
    v_xor_b32 v239, 96, v236
    s_lshl_b32 s82, s82, 9
    s_add_u32 s84, s49, 40960
    s_mov_b32 s33, 1103233024
    v_mov_b32 v229, 1
    v_and_b32 v32, -4, v32
    v_lshlrev_b32 v48, 4, v212
    v_and_b32 v40, -4, v40
    v_lshlrev_b32 v56, 4, v220
    v_lshl_or_b32 v72, v72, 16, v212
    v_lshl_add_u32 v80, v64, 2, s31
    v_lshl_add_u32 v88, v64, 5, s32
    v_and_b32 v33, -4, v33
    v_lshlrev_b32 v49, 4, v213
    v_and_b32 v41, -4, v41
    v_lshlrev_b32 v57, 4, v221
    v_lshl_or_b32 v73, v73, 16, v213
    v_lshl_add_u32 v81, v65, 2, s31
    v_lshl_add_u32 v89, v65, 5, s32
    v_and_b32 v34, -4, v34
    v_lshlrev_b32 v50, 4, v214
    v_and_b32 v42, -4, v42
    v_lshlrev_b32 v58, 4, v222
    v_lshl_or_b32 v74, v74, 16, v214
    v_lshl_add_u32 v82, v66, 2, s31
    v_lshl_add_u32 v90, v66, 5, s32
    v_and_b32 v35, -4, v35
    v_lshlrev_b32 v51, 4, v215
    v_and_b32 v43, -4, v43
    v_lshlrev_b32 v59, 4, v223
    v_lshl_or_b32 v75, v75, 16, v215
    v_lshl_add_u32 v83, v67, 2, s31
    v_lshl_add_u32 v91, v67, 5, s32
    v_and_b32 v36, -4, v36
    v_lshlrev_b32 v52, 4, v216
    v_and_b32 v44, -4, v44
    v_lshlrev_b32 v60, 4, v224
    v_lshl_or_b32 v76, v76, 16, v216
    v_lshl_add_u32 v84, v68, 2, s31
    v_lshl_add_u32 v92, v68, 5, s32
    v_and_b32 v37, -4, v37
    v_lshlrev_b32 v53, 4, v217
    v_and_b32 v45, -4, v45
    v_lshlrev_b32 v61, 4, v225
    v_lshl_or_b32 v77, v77, 16, v217
    v_lshl_add_u32 v85, v69, 2, s31
    v_lshl_add_u32 v93, v69, 5, s32
    v_add_u32 v236, v236, v240
    v_add_u32 v237, v237, v240
    v_add_u32 v238, v238, v240
    v_add_u32 v239, v239, v240
    s_cmp_lg_u32 s3, 0
    s_cbranch_scc1 L_noaddr6
    v_mul_u32_u24 v70, 5350, v226
    v_lshrrev_b32 v70, 19, v70
    v_mul_u32_u24 v38, 6, v218
    v_mul_u32_u24 v46, 6, v226
    v_mad_i32_i24 v78, v70, s30, v226
    v_and_b32 v38, -4, v38
    v_lshlrev_b32 v54, 4, v218
    v_and_b32 v46, -4, v46
    v_lshlrev_b32 v62, 4, v226
    v_lshl_or_b32 v78, v78, 16, v218
    v_lshl_add_u32 v86, v70, 2, s31
    v_lshl_add_u32 v94, v70, 5, s32
L_noaddr6:
    s_cmp_eq_u32 s81, 1563
    s_cbranch_scc1 L_wp0
    s_waitcnt vmcnt(2)
    s_branch L_wp1
L_wp0:
    s_waitcnt vmcnt(0)
L_wp1:
    s_waitcnt lgkmcnt(0)
    s_barrier
    s_cmp_lg_u32 s3, 0
    s_cbranch_scc1 L_nowarm
    s_mov_b32 s20, s76
    s_mov_b32 s21, s77
    s_mov_b32 s22, 24576
    s_mov_b32 s23, 0x00020000
    s_mov_b32 s48, s78
    s_mov_b32 s49, s79
    s_mov_b32 s50, 1536
    s_mov_b32 s51, 0x00020000
    s_lshr_b32 s38, s2, 3
    s_mul_i32 s38, s38, 768
    v_lshlrev_b32 v130, 7, v249
    s_mov_b64 exec, 63
    buffer_load_dword v253, v130, s[20:23], s38 offen
    s_mov_b64 exec, 0xfff
    buffer_load_dword v254, v130, s[48:51], 0 offen
    s_mov_b64 exec, -1
L_nowarm:
    buffer_load_dwordx4 v[0:3], v233, s[8:11], s82 offen
    s_add_u32 s82, s82, 16384
    buffer_load_dwordx4 v[4:7], v233, s[8:11], s82 offen
    s_add_u32 s82, s82, 16384
    buffer_load_dwordx4 v[8:11], v233, s[8:11], s82 offen
    s_add_u32 s82, s82, 16384
    buffer_load_dwordx4 v[12:15], v234, s[8:11], s82 offen
    s_add_u32 s82, s82, -48640
    s_mov_b64 s[68:69], 0
    s_mov_b64 s[72:73], 0
    s_cmp_lg_u32 s3, 0
    s_cbranch_scc1 L_filt
    ds_read2_b32 v[108:109], v38 offset0:0 offset1:1
    ds_read2_b32 v[122:123], v46 offset0:0 offset1:1
    s_waitcnt lgkmcnt(1)
    v_alignbit_b32 v108, v109, v108, v54
    v_lshlrev_b32 v38, 16, v108
    s_waitcnt lgkmcnt(0)
    v_alignbit_b32 v122, v123, v122, v62
    v_lshlrev_b32 v46, 16, v122
    v_lshrrev_b32 v109, v54, v109
    v_and_b32 v108, 0xffff0000, v108
    v_lshrrev_b32 v123, v62, v123
    v_and_b32 v122, 0xffff0000, v122
    v_sub_f32 v38, v38, v46
    v_lshlrev_b32 v109, 16, v109
    v_lshlrev_b32 v123, 16, v123
    v_sub_f32 v108, v108, v122
    v_mul_f32 v38, v38, v38
    v_sub_f32 v109, v109, v123
    v_fmac_f32 v38, v108, v108
    v_fmac_f32 v38, v109, v109
    v_cmp_nlt_f32 s[68:69], s33, v38
    s_nop 0
    s_and_b64 s[68:69], s[68:69], s[52:53]
    s_mov_b64 exec, s[68:69]
    ds_add_rtn_u32 v54, v86, v229
    s_mov_b64 exec, s[68:69]
    s_waitcnt lgkmcnt(0)
    v_cmp_lt_u32 vcc, 6, v54
    v_lshl_add_u32 v94, v54, 2, v94
    s_mov_b64 s[68:69], vcc
    s_or_b64 s[72:73], s[72:73], vcc
    s_andn2_b64 exec, exec, vcc
    ds_write_b32 v94, v78
    s_mov_b64 exec, -1
L_filt:
    ds_read2_b32 v[96:97], v32 offset0:0 offset1:1
    ds_read2_b32 v[110:111], v40 offset0:0 offset1:1
    ds_read2_b32 v[98:99], v33 offset0:0 offset1:1
    ds_read2_b32 v[112:113], v41 offset0:0 offset1:1
    ds_read2_b32 v[100:101], v34 offset0:0 offset1:1
    ds_read2_b32 v[114:115], v42 offset0:0 offset1:1
    ds_read2_b32 v[102:103], v35 offset0:0 offset1:1
    ds_read2_b32 v[116:117], v43 offset0:0 offset1:1
    ds_read2_b32 v[104:105], v36 offset0:0 offset1:1
    s_waitcnt lgkmcnt(8)
    v_alignbit_b32 v96, v97, v96, v48
    ds_read2_b32 v[118:119], v44 offset0:0 offset1:1
    s_waitcnt lgkmcnt(8)
    v_alignbit_b32 v110, v111, v110, v56
    ds_read2_b32 v[106:107], v37 offset0:0 offset1:1
    s_waitcnt lgkmcnt(8)
    v_alignbit_b32 v98, v99, v98, v49
    ds_read2_b32 v[120:121], v45 offset0:0 offset1:1
    s_waitcnt lgkmcnt(8)
    v_alignbit_b32 v112, v113, v112, v57
    s_waitcnt lgkmcnt(7)
    v_alignbit_b32 v100, v101, v100, v50
    v_lshlrev_b32 v32, 16, v96
    s_waitcnt lgkmcnt(6)
    v_alignbit_b32 v114, v115, v114, v58
    v_lshlrev_b32 v40, 16, v110
    v_lshlrev_b32 v33, 16, v98
    v_lshlrev_b32 v41, 16, v112
    v_lshlrev_b32 v34, 16, v100
    v_lshlrev_b32 v42, 16, v114
    v_lshrrev_b32 v97, v48, v97
    v_and_b32 v96, 0xffff0000, v96
    v_lshrrev_b32 v111, v56, v111
    v_and_b32 v110, 0xffff0000, v110
    v_sub_f32 v32, v32, v40
    v_lshrrev_b32 v99, v49, v99
    v_and_b32 v98, 0xffff0000, v98
    v_lshrrev_b32 v113, v57, v113
    v_and_b32 v112, 0xffff0000, v112
    v_sub_f32 v33, v33, v41
    v_lshrrev_b32 v101, v50, v101
    v_and_b32 v100, 0xffff0000, v100
    v_lshrrev_b32 v115, v58, v115
    v_and_b32 v114, 0xffff0000, v114
    v_sub_f32 v34, v34, v42
    v_lshlrev_b32 v97, 16, v97
    v_lshlrev_b32 v111, 16, v111
    v_sub_f32 v96, v96, v110
    v_mul_f32 v32, v32, v32
    v_lshlrev_b32 v99, 16, v99
    v_lshlrev_b32 v113, 16, v113
    v_sub_f32 v98, v98, v112
    v_mul_f32 v33, v33, v33
    v_lshlrev_b32 v101, 16, v101
    v_lshlrev_b32 v115, 16, v115
    v_sub_f32 v100, v100, v114
    v_mul_f32 v34, v34, v34
    v_sub_f32 v97, v97, v111
    v_fmac_f32 v32, v96, v96
    v_sub_f32 v99, v99, v113
    v_fmac_f32 v33, v98, v98
    v_sub_f32 v101, v101, v115
    v_fmac_f32 v34, v100, v100
    v_fmac_f32 v32, v97, v97
    v_fmac_f32 v33, v99, v99
    v_fmac_f32 v34, v101, v101
    v_cmp_nlt_f32 s[56:57], s33, v32
    v_cmp_nlt_f32 s[58:59], s33, v33
    v_cmp_nlt_f32 s[60:61], s33, v34
    s_mov_b64 exec, s[56:57]
    ds_add_rtn_u32 v48, v80, v229
    s_mov_b64 exec, s[58:59]
    ds_add_rtn_u32 v49, v81, v229
    s_mov_b64 exec, s[60:61]
    ds_add_rtn_u32 v50, v82, v229
    s_mov_b64 exec, -1
    buffer_load_dwordx4 v[16:19], v233, s[8:11], s82 offen
    s_add_u32 s82, s82, 16384
    buffer_load_dwordx4 v[20:23], v233, s[8:11], s82 offen
    s_add_u32 s82, s82, 16384
    buffer_load_dwordx4 v[24:27], v233, s[8:11], s82 offen
    s_add_u32 s82, s82, 16384
    buffer_load_dwordx4 v[28:31], v234, s[8:11], s82 offen
    s_add_u32 s82, s82, -48640
    s_waitcnt lgkmcnt(6)
    v_alignbit_b32 v104, v105, v104, v52
    s_waitcnt lgkmcnt(5)
    v_alignbit_b32 v118, v119, v118, v60
    s_waitcnt lgkmcnt(4)
    v_alignbit_b32 v106, v107, v106, v53
    s_waitcnt lgkmcnt(3)
    v_alignbit_b32 v120, v121, v120, v61
    v_lshlrev_b32 v36, 16, v104
    v_lshlrev_b32 v44, 16, v118
    v_alignbit_b32 v102, v103, v102, v51
    v_alignbit_b32 v116, v117, v116, v59
    v_lshlrev_b32 v37, 16, v106
    v_lshlrev_b32 v45, 16, v120
    v_lshrrev_b32 v105, v52, v105
    v_and_b32 v104, 0xffff0000, v104
    v_lshrrev_b32 v119, v60, v119
    v_and_b32 v118, 0xffff0000, v118
    v_sub_f32 v36, v36, v44
    v_lshlrev_b32 v35, 16, v102
    v_lshlrev_b32 v43, 16, v116
    v_lshrrev_b32 v107, v53, v107
    v_and_b32 v106, 0xffff0000, v106
    v_lshrrev_b32 v121, v61, v121
    v_and_b32 v120, 0xffff0000, v120
    v_sub_f32 v37, v37, v45
    v_lshlrev_b32 v105, 16, v105
    v_lshlrev_b32 v119, 16, v119
    v_sub_f32 v104, v104, v118
    v_mul_f32 v36, v36, v36
    v_lshrrev_b32 v103, v51, v103
    v_and_b32 v102, 0xffff0000, v102
    v_lshrrev_b32 v117, v59, v117
    v_and_b32 v116, 0xffff0000, v116
    v_sub_f32 v35, v35, v43
    v_lshlrev_b32 v107, 16, v107
    v_lshlrev_b32 v121, 16, v121
    v_sub_f32 v106, v106, v120
    v_mul_f32 v37, v37, v37
    v_sub_f32 v105, v105, v119
    v_fmac_f32 v36, v104, v104
    v_lshlrev_b32 v103, 16, v103
    v_lshlrev_b32 v117, 16, v117
    v_sub_f32 v102, v102, v116
    v_mul_f32 v35, v35, v35
    v_sub_f32 v107, v107, v121
    v_fmac_f32 v37, v106, v106
    v_fmac_f32 v36, v105, v105
    v_sub_f32 v103, v103, v117
    v_fmac_f32 v35, v102, v102
    v_fmac_f32 v37, v107, v107
    v_cmp_nlt_f32 s[64:65], s33, v36
    v_fmac_f32 v35, v103, v103
    v_cmp_nlt_f32 s[66:67], s33, v37
    s_and_b64 s[64:65], s[64:65], s[70:71]
    v_cmp_nlt_f32 s[62:63], s33, v35
    s_and_b64 s[66:67], s[66:67], s[70:71]
    s_mov_b64 exec, s[62:63]
    ds_add_rtn_u32 v51, v83, v229
    s_mov_b64 exec, s[64:65]
    ds_add_rtn_u32 v52, v84, v229
    s_mov_b64 exec, s[66:67]
    ds_add_rtn_u32 v53, v85, v229
    s_mov_b64 exec, s[56:57]
    s_waitcnt lgkmcnt(5)
    v_cmp_lt_u32 vcc, 6, v48
    v_lshl_add_u32 v88, v48, 2, v88
    s_mov_b64 s[56:57], vcc
    s_or_b64 s[72:73], s[72:73], vcc
    s_andn2_b64 exec, exec, vcc
    ds_write_b32 v88, v72
    s_mov_b64 exec, s[58:59]
    s_waitcnt lgkmcnt(5)
    v_cmp_lt_u32 vcc, 6, v49
    v_lshl_add_u32 v89, v49, 2, v89
    s_mov_b64 s[58:59], vcc
    s_or_b64 s[72:73], s[72:73], vcc
    s_andn2_b64 exec, exec, vcc
    ds_write_b32 v89, v73
    s_mov_b64 exec, s[60:61]
    s_waitcnt lgkmcnt(5)
    v_cmp_lt_u32 vcc, 6, v50
    v_lshl_add_u32 v90, v50, 2, v90
    s_mov_b64 s[60:61], vcc
    s_or_b64 s[72:73], s[72:73], vcc
    s_andn2_b64 exec, exec, vcc
    ds_write_b32 v90, v74
    s_mov_b64 exec, s[62:63]
    s_waitcnt lgkmcnt(5)
    v_cmp_lt_u32 vcc, 6, v51
    v_lshl_add_u32 v91, v51, 2, v91
    s_mov_b64 s[62:63], vcc
    s_or_b64 s[72:73], s[72:73], vcc
    s_andn2_b64 exec, exec, vcc
    ds_write_b32 v91, v75
    s_mov_b64 exec, s[64:65]
    s_waitcnt lgkmcnt(5)
    v_cmp_lt_u32 vcc, 6, v52
    v_lshl_add_u32 v92, v52, 2, v92
    s_mov_b64 s[64:65], vcc
    s_or_b64 s[72:73], s[72:73], vcc
    s_andn2_b64 exec, exec, vcc
    ds_write_b32 v92, v76
    s_mov_b64 exec, s[66:67]
    s_waitcnt lgkmcnt(5)
    v_cmp_lt_u32 vcc, 6, v53
    v_lshl_add_u32 v93, v53, 2, v93
    s_mov_b64 s[66:67], vcc
    s_or_b64 s[72:73], s[72:73], vcc
    s_andn2_b64 exec, exec, vcc
    ds_write_b32 v93, v77
    s_mov_b64 exec, -1
    s_cmp_eq_u64 s[72:73], 0
    s_cbranch_scc0 L_ovf
L_noovf:
    s_waitcnt lgkmcnt(0)
    s_waitcnt vmcnt(8)
    s_barrier
    s_cmp_ge_u32 s3, 4
    s_cbranch_scc1 L_stage
    v_lshrrev_b32 v33, 1, v228
    v_lshl_add_u32 v34, v33, 2, s31
    v_mov_b32 v35, 151040
    ds_read_b32 v38, v34
    ds_read_b32 v56, v34 offset:512
    ds_read_b32 v39, v35
    v_add_u32 v32, 151072, v232
    ds_read_b128 v[40:43], v32
    ds_read_b128 v[52:55], v32 offset:4096
    v_lshl_add_u32 v58, v228, 2, s31
    ds_read_b32 v57, v58
    v_and_b32 v49, 1, v228
    v_cmp_eq_u32 vcc, 0, v49
    s_mov_b32 s37, 0x7fffff
    v_mov_b32 v48, s85
    v_mov_b32 v59, s86
    v_mov_b32 v60, s87
    v_mov_b32 v61, s88
    s_lshl_b32 s38, s28, 13
    v_lshlrev_b32 v36, 4, v228
    s_lshl_b32 s39, s28, 4
    s_add_u32 s48, s38, 4096
    v_add_u32 v37, 159264, v36
    s_add_u32 s39, s39, 2097152
    v_lshlrev_b32 v36, 12, v228
    s_waitcnt lgkmcnt(5)
    v_min_u32 v38, 15, v38
    s_waitcnt lgkmcnt(4)
    v_min_u32 v56, 15, v56
    s_waitcnt lgkmcnt(3)
    v_lshl_or_b32 v38, v39, 4, v38
    v_lshl_or_b32 v56, v39, 4, v56
    s_waitcnt lgkmcnt(2)
    v_cndmask_b32 v40, v40, v38, vcc
    v_and_or_b32 v40, v40, s37, v48
    s_waitcnt lgkmcnt(1)
    v_cndmask_b32 v52, v52, v56, vcc
    v_and_or_b32 v41, v41, s37, v59
    v_and_or_b32 v42, v42, s37, v60
    v_and_or_b32 v43, v43, s37, v61
    s_waitcnt lgkmcnt(0)
    v_cmp_lt_u32 s[56:57], 7, v57
    v_and_or_b32 v52, v52, s37, v48
    v_and_or_b32 v53, v53, s37, v59
    v_and_or_b32 v54, v54, s37, v60
    v_and_or_b32 v55, v55, s37, v61
    buffer_store_dwordx4 v[40:43], v232, s[16:19], s38 offen sc1
    s_cmp_eq_u64 s[56:57], 0
    buffer_store_dwordx4 v[52:55], v232, s[16:19], s48 offen sc1
    s_cbranch_scc0 L_e2pub
    s_branch L_staged
L_stage:
    s_mov_b32 s20, s76
    s_mov_b32 s21, s77
    s_mov_b32 s22, 24576
    s_mov_b32 s23, 0x00020000
    s_mov_b32 exec_hi, 0xffff
    s_add_u32 m0, s84, 0
    s_add_u32 s48, s83, 0
    buffer_load_dwordx4 v236, s[20:23], s48 offen lds
    s_add_u32 m0, s84, 768
    s_add_u32 s48, s83, 768
    buffer_load_dwordx4 v237, s[20:23], s48 offen lds
    s_add_u32 m0, s84, 1536
    s_add_u32 s48, s83, 1536
    buffer_load_dwordx4 v236, s[20:23], s48 offen lds
    s_add_u32 m0, s84, 2304
    s_add_u32 s48, s83, 2304
    buffer_load_dwordx4 v237, s[20:23], s48 offen lds
    s_add_u32 m0, s84, 3072
    s_add_u32 s48, s83, 3072
    buffer_load_dwordx4 v238, s[20:23], s48 offen lds
    s_add_u32 m0, s84, 3840
    s_add_u32 s48, s83, 3840
    buffer_load_dwordx4 v239, s[20:23], s48 offen lds
    s_add_u32 m0, s84, 4608
    s_add_u32 s48, s83, 4608
    buffer_load_dwordx4 v238, s[20:23], s48 offen lds
    s_add_u32 m0, s84, 5376
    s_add_u32 s48, s83, 5376
    buffer_load_dwordx4 v239, s[20:23], s48 offen lds
    s_mov_b64 exec, -1
    s_cmp_gt_u32 s3, 5
    s_cbranch_scc1 L_staged
    s_cmp_eq_u32 s3, 5
    s_cbranch_scc1 L_role1
    s_mov_b32 s72, s78
    s_mov_b32 s73, s79
    s_mov_b32 s74, 1536
    s_mov_b32 s75, 0x00020000
    s_mov_b64 exec, 0xffffff
    s_mov_b32 m0, 20480
    s_movk_i32 s48, 384
    buffer_load_dwordx4 v231, s[72:75], 0 offen lds
    s_mov_b32 m0, 20896
    s_movk_i32 s49, 768
    buffer_load_dwordx4 v231, s[72:75], s48 offen lds
    s_mov_b32 m0, 21312
    s_movk_i32 s48, 1152
    buffer_load_dwordx4 v231, s[72:75], s49 offen lds
    s_mov_b32 m0, 21728
    s_nop 0
    buffer_load_dwordx4 v231, s[72:75], s48 offen lds
    s_mov_b64 exec, -1
    s_branch L_staged
L_role1:
    v_lshlrev_b32 v50, 2, v249
    s_mul_i32 s53, s29, 6
    s_mov_b32 m0, 23680
    s_nop 0
    buffer_load_dword v50, s[24:27], s53 offen lds
    buffer_load_dword v50, s[24:27], s53 offen offset:256 lds
    buffer_load_dword v50, s[24:27], s53 offen offset:512 lds
L_staged:
    v_and_b32 v56, 31, v228
    v_bfe_u32 v57, v228, 5, 2
    v_lshrrev_b32 v58, 2, v56
    v_cmp_eq_u32 vcc, v57, v58
    v_lshlrev_b32 v58, 4, v56
    v_and_b32 v40, 15, v249
    s_lshl_b32 s64, s3, 9
    s_lshl_b32 s68, s3, 5
    v_lshrrev_b32 v195, 1, v249
    v_and_b32 v196, 1, v249
    v_and_b32 v58, 48, v58
    v_mov_b32 v60, 0xffff
    v_mov_b32 v61, 0
    v_lshrrev_b32 v43, 4, v249
    v_lshrrev_b32 v44, 2, v40
    v_mov_b32 v32, 2147516415
    v_mov_b32 v33, 2147516415
    v_lshl_add_u32 v34, v249, 3, s64
    v_add_u32 v195, s68, v195
    v_lshlrev_b32 v196, 4, v196
    s_lshl_b32 s69, s28, 12
    v_and_b32 v35, 31, v249
    v_lshlrev_b64 v[60:61], v58, v[60:61]
    v_and_b32 v56, 0x7f, v228
    v_and_b32 v41, 3, v249
    v_and_b32 v42, 7, v249
    v_and_b32 v43, 2, v43
    v_mul_u32_u24 v44, 416, v44
    v_mov_b32 v52, 0
    v_mov_b32 v53, 0
    v_mov_b32 v54, 0
    v_mov_b32 v55, 0
    ds_write_b64 v34, v[32:33]
    ds_write_b128 v232, v[52:55] offset:4096
    ds_write_b128 v232, v[52:55] offset:12288
    s_lshl_b32 s38, s40, 16
    s_and_b32 s39, s40, 0xffff0000
    s_lshl_b32 s68, s28, 5
    s_add_u32 s69, s69, 2097152
    v_lshl_add_u32 v204, v195, 13, v196
    v_lshlrev_b32 v205, 4, v195
    v_mov_b32 v36, 0
    v_lshlrev_b32 v35, 2, v35
    v_cndmask_b32 v60, 0, v60, vcc
    v_cndmask_b32 v61, 0, v61, vcc
    v_lshlrev_b32 v56, 3, v56
    s_lshl_b32 s40, s41, 16
    v_xor_b32 v43, v42, v43
    v_lshlrev_b32 v247, 8, v41
    v_lshl_add_u32 v44, v41, 3, v44
    s_and_b32 s41, s41, 0xffff0000
    s_or_b32 s9, s9, 33554432
    s_or_b32 s13, s13, 8388608
    v_add_u32 v204, s68, v204
    v_add_u32 v205, s69, v205
    ds_write_b32 v35, v36 offset:23552
    ds_write_b64 v56, v[60:61] offset:22528
    s_mov_b32 s20, s44
    s_mov_b32 s21, s45
    s_mov_b32 s22, 12800000
    s_mov_b32 s23, 0x00020000
    s_mov_b32 s55, 1
    v_lshlrev_b32 v235, 4, v43
    v_lshlrev_b32 v237, 4, v43
    v_add_u32 v247, 22528, v247
    v_add_u32 v248, 20480, v44
    s_cmp_lt_u32 s3, 4
    s_cbranch_scc1 L_now2w
    s_waitcnt vmcnt(0)
L_now2w:
    s_waitcnt lgkmcnt(0)
    s_barrier
    buffer_load_dwordx4 v[210:213], v204, s[16:19], 0 offen sc1
    buffer_load_dwordx4 v[214:217], v205, s[16:19], 0 offen sc1
    v_lshrrev_b32 v160, 4, v249
    v_bfe_u32 v161, v249, 2, 2
    v_and_b32 v163, 1, v160
    v_lshl_add_u32 v164, v163, 3, v161
    v_and_b32 v162, 3, v249
    v_mul_u32_u24 v164, 384, v164
    v_lshl_add_u32 v164, v162, 3, v164
    v_lshrrev_b32 v165, 1, v160
    v_lshrrev_b32 v161, 1, v161
    v_lshl_add_u32 v164, v165, 14, v164
    v_lshl_add_u32 v161, v163, 1, v161
    v_add_u32 v164, 40960, v164
    v_xor_b32 v166, 0, v161
    v_xor_b32 v167, 1, v161
    v_xor_b32 v168, 2, v161
    v_xor_b32 v169, 3, v161
    v_lshl_add_u32 v166, v166, 5, v164
    v_lshl_add_u32 v167, v167, 5, v164
    v_lshl_add_u32 v168, v168, 5, v164
    v_lshl_add_u32 v169, v169, 5, v164
    ds_read_b64_tr_b16 v[80:81], v166 offset:256
    ds_read_b64_tr_b16 v[82:83], v166 offset:1792
    ds_read_b64_tr_b16 v[84:85], v166 offset:33024
    ds_read_b64_tr_b16 v[86:87], v166 offset:34560
    ds_read_b64_tr_b16 v[72:73], v166 offset:128
    ds_read_b64_tr_b16 v[74:75], v166 offset:1664
    ds_read_b64_tr_b16 v[76:77], v166 offset:32896
    ds_read_b64_tr_b16 v[78:79], v166 offset:34432
    v_bfe_u32 v41, v249, 3, 2
    v_lshrrev_b32 v40, 5, v249
    v_lshlrev_b32 v43, 10, v41
    v_and_b32 v42, 7, v249
    v_lshl_add_u32 v43, v40, 7, v43
    v_lshl_add_u32 v43, v42, 4, v43
    v_add_u32 v44, s34, v43
    v_xor_b32 v45, 32, v44
    v_xor_b32 v46, 64, v44
    v_xor_b32 v47, 96, v44
    ds_read_b64_tr_b16 v[64:65], v166 offset:0
    ds_read_b64_tr_b16 v[66:67], v166 offset:1536
    ds_read_b64_tr_b16 v[68:69], v166 offset:32768
    ds_read_b64_tr_b16 v[70:71], v166 offset:34304
    ds_read_b64_tr_b16 v[104:105], v167 offset:256
    ds_read_b64_tr_b16 v[106:107], v167 offset:1792
    ds_read_b64_tr_b16 v[108:109], v167 offset:33024
    ds_read_b64_tr_b16 v[110:111], v167 offset:34560
    ds_read_b64_tr_b16 v[96:97], v167 offset:128
    ds_read_b64_tr_b16 v[98:99], v167 offset:1664
    ds_read_b64_tr_b16 v[100:101], v167 offset:32896
    ds_read_b64_tr_b16 v[102:103], v167 offset:34432
    ds_read_b64_tr_b16 v[88:89], v167 offset:0
    ds_read_b64_tr_b16 v[90:91], v167 offset:1536
    ds_read_b64_tr_b16 v[92:93], v167 offset:32768
    ds_read_b64_tr_b16 v[94:95], v167 offset:34304
    ds_read_b64_tr_b16 v[128:129], v168 offset:256
    ds_read_b64_tr_b16 v[130:131], v168 offset:1792
    ds_read_b64_tr_b16 v[132:133], v168 offset:33024
    ds_read_b64_tr_b16 v[134:135], v168 offset:34560
    ds_read_b64_tr_b16 v[120:121], v168 offset:128
    ds_read_b64_tr_b16 v[122:123], v168 offset:1664
    ds_read_b64_tr_b16 v[124:125], v168 offset:32896
    ds_read_b64_tr_b16 v[126:127], v168 offset:34432
    ds_read_b64_tr_b16 v[112:113], v168 offset:0
    ds_read_b64_tr_b16 v[114:115], v168 offset:1536
    ds_read_b64_tr_b16 v[116:117], v168 offset:32768
    ds_read_b64_tr_b16 v[118:119], v168 offset:34304
    ds_read_b64_tr_b16 v[152:153], v169 offset:256
    ds_read_b64_tr_b16 v[154:155], v169 offset:1792
    ds_read_b64_tr_b16 v[156:157], v169 offset:33024
    ds_read_b64_tr_b16 v[158:159], v169 offset:34560
    ds_read_b64_tr_b16 v[144:145], v169 offset:128
    ds_read_b64_tr_b16 v[146:147], v169 offset:1664
    ds_read_b64_tr_b16 v[148:149], v169 offset:32896
    ds_read_b64_tr_b16 v[150:151], v169 offset:34432
    ds_read_b64_tr_b16 v[136:137], v169 offset:0
    ds_read_b64_tr_b16 v[138:139], v169 offset:1536
    ds_read_b64_tr_b16 v[140:141], v169 offset:32768
    ds_read_b64_tr_b16 v[142:143], v169 offset:34304
    s_waitcnt vmcnt(2)
    ds_write_b128 v44, v[0:3] offset:0
    ds_write_b128 v45, v[4:7] offset:256
    ds_write_b128 v46, v[8:11] offset:512
    ds_write_b128 v47, v[12:15] offset:768
    ds_write_b128 v44, v[16:19] offset:4096
    ds_write_b128 v45, v[20:23] offset:4352
    ds_write_b128 v46, v[24:27] offset:4608
    ds_write_b128 v47, v[28:31] offset:4864
    s_lshl_b32 s67, s3, 9
    v_lshrrev_b32 v165, 3, v249
    v_and_b32 v164, 15, v249
    v_lshl_add_u32 v242, v165, 2, s67
    v_lshrrev_b32 v165, 4, v249
    v_lshlrev_b32 v162, 3, v164
    v_lshl_add_u32 v162, v165, 8, v162
    ds_read_b64 v[252:253], v162 offset:22528
    v_lshrrev_b32 v167, 2, v164
    v_and_b32 v170, 1, v165
    v_and_b32 v163, 1, v167
    v_bfe_u32 v161, v249, 2, 3
    v_lshlrev_b32 v170, 5, v170
    v_lshlrev_b32 v163, 1, v163
    v_lshlrev_b32 v254, 7, v161
    v_lshl_add_u32 v170, v165, 9, v170
    v_xor_b32 v163, v163, v165
    v_lshrrev_b32 v161, 1, v161
    s_lshl_b32 s64, s3, 10
    v_and_b32 v202, 48, v249
    v_and_b32 v166, 3, v249
    s_lshl_b32 s65, s3, 8
    v_lshl_add_u32 v170, v164, 1, v170
    v_lshlrev_b32 v163, 4, v163
    v_lshl_add_u32 v254, v161, 5, v254
    s_add_u32 s64, s64, 4096
    v_lshrrev_b32 v175, 2, v202
    v_lshl_add_u32 v168, v165, 2, v167
    v_lshl_add_u32 v169, v165, 2, v166
    s_add_u32 s65, s65, 12288
    v_add_u32 v243, s34, v170
    v_lshl_add_u32 v163, v164, 7, v163
    v_lshl_add_u32 v254, v166, 3, v254
    v_and_b32 v195, 1, v249
    v_mov_b32 v200, 4
    v_mov_b32 v193, 6
    v_lshlrev_b32 v201, 2, v164
    v_xor_b32 v174, 15, v164
    v_xor_b32 v175, 15, v175
    v_lshl_add_u32 v239, v168, 2, s67
    v_lshl_add_u32 v241, v169, 3, s64
    v_lshl_add_u32 v240, v165, 3, s65
    v_xor_b32 v244, 32, v243
    v_add_u32 v245, s34, v163
    v_add_u32 v254, 32768, v254
    s_waitcnt lgkmcnt(0)
    v_and_b32 v252, 0x3f803f80, v252
    v_and_b32 v253, 0x3f803f80, v253
    s_waitcnt vmcnt(0)
    s_mov_b32 s68, 0
    s_mov_b64 s[66:67], -1
L_px_chk:
    s_mov_b64 exec, s[66:67]
    v_xor_b32 v206, s85, v210
    v_xor_b32 v207, s86, v211
    v_xor_b32 v208, s87, v212
    v_xor_b32 v209, s88, v213
    v_or3_b32 v206, v206, v207, v208
    v_or_b32 v206, v206, v209
    v_cmp_le_u32 vcc, 0x800000, v206
    s_nop 0
    s_and_b64 s[66:67], vcc, exec
    s_cbranch_scc0 L_px_ok
    s_add_u32 s68, s68, 1
    s_cmp_ge_u32 s68, 131072
    s_cbranch_scc1 L_px_ok
    s_mov_b64 exec, s[66:67]
    buffer_load_dwordx4 v[210:213], v204, s[16:19], 0 offen sc1
    buffer_load_dwordx4 v[214:217], v205, s[16:19], 0 offen sc1
    s_waitcnt vmcnt(0)
    s_branch L_px_chk
L_px_ok:
    s_mov_b64 exec, -1
L_pass:
    v_mov_b32_dpp v194, v210 quad_perm:[0,0,2,2] row_mask:0xf bank_mask:0xf
    v_and_b32 v196, 15, v194
    v_bfe_u32 v197, v194, 4, 12
    v_cmp_lt_u32 s[56:57], 7, v196
    s_cmp_eq_u32 s55, 0
    s_cbranch_scc1 L_hdr_done
    v_mul_u32_u24 v198, 3, v195
    v_sub_u32 v198, v196, v198
    v_add_u32 v199, 3, v195
    v_med3_i32 v198, v198, 0, v199
    v_bfm_b32 v198, v198, 0
    v_xor_b32 v199, 1, v195
    v_lshlrev_b32 v250, v199, v198
L_hdr_done:
    v_and_b32 v218, 1, v250
    v_lshrrev_b32 v226, 14, v210
    v_mul_u32_u24_sdwa v170, v210, v193 dst_sel:DWORD dst_unused:UNUSED_PAD src0_sel:WORD_0 src1_sel:DWORD
    v_and_b32 v219, 2, v250
    v_lshrrev_b32 v227, 14, v211
    v_mul_u32_u24_sdwa v171, v211, v193 dst_sel:DWORD dst_unused:UNUSED_PAD src0_sel:WORD_0 src1_sel:DWORD
    v_and_b32 v220, 4, v250
    v_lshrrev_b32 v228, 14, v212
    v_mul_u32_u24_sdwa v172, v212, v193 dst_sel:DWORD dst_unused:UNUSED_PAD src0_sel:WORD_0 src1_sel:DWORD
    v_and_b32 v221, 8, v250
    v_lshrrev_b32 v229, 14, v213
    v_mul_u32_u24_sdwa v173, v213, v193 dst_sel:DWORD dst_unused:UNUSED_PAD src0_sel:WORD_0 src1_sel:DWORD
    v_cmp_ne_u32 s[64:65], 0, v218
    v_and_b32 v226, 60, v226
    v_and_b32 v170, -4, v170
    v_cmp_ne_u32 s[66:67], 0, v219
    v_and_b32 v227, 60, v227
    v_and_b32 v171, -4, v171
    v_cmp_ne_u32 s[68:69], 0, v220
    v_and_b32 v228, 60, v228
    v_and_b32 v172, -4, v172
    v_cmp_ne_u32 s[70:71], 0, v221
    v_and_b32 v229, 60, v229
    v_and_b32 v173, -4, v173
    s_mov_b64 exec, s[64:65]
    ds_add_rtn_u32 v218, v226, v200 offset:23552
    buffer_load_dwordx2 v[176:177], v170, s[24:27], 0 offen
    s_mov_b64 exec, s[66:67]
    ds_add_rtn_u32 v219, v227, v200 offset:23552
    buffer_load_dwordx2 v[178:179], v171, s[24:27], 0 offen
    s_mov_b64 exec, s[68:69]
    ds_add_rtn_u32 v220, v228, v200 offset:23552
    buffer_load_dwordx2 v[180:181], v172, s[24:27], 0 offen
    s_mov_b64 exec, s[70:71]
    ds_add_rtn_u32 v221, v229, v200 offset:23552
    buffer_load_dwordx2 v[182:183], v173, s[24:27], 0 offen
    s_mov_b64 exec, -1
    s_cmp_eq_u64 s[56:57], 0
    s_cbranch_scc0 L_p1_rare
L_p1_done:
    s_waitcnt lgkmcnt(0)
    s_barrier
    ds_read_b32 v203, v201 offset:23552
    ds_read_b128 v[160:163], v202 offset:23552
    s_cmp_eq_u32 s55, 0
    s_waitcnt lgkmcnt(1)
    v_lshl_add_u32 v164, v203, 2, v174
    s_cbranch_scc1 L_ranked
    s_waitcnt lgkmcnt(0)
    v_lshl_add_u32 v160, v160, 2, v175
    v_lshl_add_u32 v161, v161, 2, v175
    v_mov_b32 v166, 0
    v_cmp_gt_u32 s[64:65], v160, v164
    v_subrev_u32 v161, 1, v161
    v_lshl_add_u32 v162, v162, 2, v175
    v_addc_co_u32 v166, vcc, 0, v166, s[64:65]
    v_cmp_gt_u32 s[66:67], v161, v164
    v_subrev_u32 v162, 2, v162
    v_lshl_add_u32 v163, v163, 2, v175
    v_addc_co_u32 v166, vcc, 0, v166, s[66:67]
    v_cmp_gt_u32 s[68:69], v162, v164
    v_subrev_u32 v163, 3, v163
    v_cmp_gt_u32 s[70:71], v163, v164
    v_addc_co_u32 v166, vcc, 0, v166, s[68:69]
    s_nop 1
    v_addc_co_u32 v166, vcc, 0, v166, s[70:71]
    v_mov_b32 v167, v166
    s_nop 1
    v_permlane32_swap_b32 v166, v167
    v_add_u32 v166, v166, v167
    v_mov_b32 v167, v166
    s_nop 1
    v_permlane16_swap_b32 v166, v167
    v_add_lshl_u32 v251, v166, v167, 2
L_ranked:
    s_waitcnt lgkmcnt(0)
    ds_permute_b32 v168, v251, v164
    v_xor_b32 v167, 60, v251
    v_cmp_lt_u32 vcc, 28, v251
    s_xor_b32 s67, s3, 4
    s_sub_u32 s66, 15, s67
    v_cndmask_b32 v166, v251, v167, vcc
    v_xor_b32 v166, 16, v166
    v_lshlrev_b32 v166, 7, v166
    v_add_u32 v165, 510, v166
    v_addc_co_u32 v165, s[64:65], 0, v165, vcc
    v_lshl_or_b32 v165, v165, 16, v166
    s_sub_u32 s68, 15, s3
    v_and_b32 v198, 1, v250
    v_lshlrev_b32 v170, 7, v210
    v_lshlrev_b32 v171, 7, v211
    v_lshlrev_b32 v172, 7, v212
    v_lshlrev_b32 v173, 7, v213
    s_mov_b32 s70, 0x38000000
    v_and_b32 v210, 0x7fffff, v210
    v_and_b32 v211, 0x7fffff, v211
    v_and_b32 v212, 0x7fffff, v212
    v_and_b32 v213, 0x7fffff, v213
    s_mov_b32 s71, 2.0
    v_and_or_b32 v210, v170, s70, v210
    v_and_or_b32 v211, v171, s70, v211
    v_and_or_b32 v212, v172, s70, v212
    v_and_or_b32 v213, v173, s70, v213
    s_waitcnt lgkmcnt(0)
    ds_bpermute_b32 v169, v167, v168
    v_readlane_b32 s64, v168, s67
    v_readlane_b32 s65, v168, s66
    v_readlane_b32 s66, v168, s3
    v_readlane_b32 s67, v168, s68
    s_and_b32 s43, s64, 15
    s_and_b32 s62, s65, 15
    s_lshr_b32 s66, s66, 4
    s_lshr_b32 s67, s67, 4
    s_lshr_b32 s64, s64, 4
    s_lshr_b32 s65, s65, 4
    s_add_u32 s66, s66, s67
    s_add_u32 s30, s64, s65
    s_min_u32 s66, s66, 128
    s_min_u32 s30, s30, 128
    s_add_u32 s66, s66, 15
    s_add_u32 s31, s30, 15
    s_lshr_b32 s35, s66, 4
    s_lshr_b32 s31, s31, 4
    s_mul_i32 s64, s31, 5
    s_lshl_b32 s35, s35, 1
    s_sub_i32 s35, s64, s35
    v_cmp_ne_u32 s[64:65], 0, v198
    v_and_b32 v198, 2, v250
    v_cmp_ne_u32 s[66:67], 0, v198
    v_and_b32 v198, 4, v250
    v_cmp_ne_u32 s[68:69], 0, v198
    s_add_i32 s35, s35, -1
    s_waitcnt lgkmcnt(0)
    v_lshrrev_b32 v169, 2, v169
    v_and_b32 v169, -4, v169
    v_cndmask_b32 v169, 0, v169, vcc
    v_add_u32 v165, v165, v169
    ds_bpermute_b32 v160, v226, v165
    ds_bpermute_b32 v161, v227, v165
    ds_bpermute_b32 v162, v228, v165
    ds_bpermute_b32 v163, v229, v165
    v_and_b32 v198, 8, v250
    s_sub_u32 s43, 15, s43
    s_sub_u32 s62, 15, s62
    s_ashr_i32 s35, s35, 2
    v_cmp_ne_u32 s[48:49], 0, v198
    s_mov_b64 exec, s[64:65]
    s_waitcnt lgkmcnt(3)
    v_add_u32_sdwa v218, v160, v218 dst_sel:DWORD dst_unused:UNUSED_PAD src0_sel:WORD_0 src1_sel:DWORD
    v_lshlrev_b32 v199, 14, v160
    v_and_or_b32 v210, v199, s71, v210
    v_cmp_lt_u32_sdwa vcc, v218, v160 src0_sel:DWORD src1_sel:WORD_1
    s_nop 0
    s_mov_b64 exec, vcc
    ds_write_b32 v218, v210 offset:0
    v_xor_b32 v250, 1, v250
    s_mov_b64 s[72:73], exec
    s_mov_b64 exec, s[66:67]
    s_waitcnt lgkmcnt(3)
    v_add_u32_sdwa v219, v161, v219 dst_sel:DWORD dst_unused:UNUSED_PAD src0_sel:WORD_0 src1_sel:DWORD
    v_lshlrev_b32 v199, 14, v161
    v_and_or_b32 v211, v199, s71, v211
    v_cmp_lt_u32_sdwa vcc, v219, v161 src0_sel:DWORD src1_sel:WORD_1
    s_nop 0
    s_mov_b64 exec, vcc
    ds_write_b32 v219, v211 offset:0
    v_xor_b32 v250, 2, v250
    s_mov_b64 s[74:75], exec
    s_mov_b64 exec, s[68:69]
    s_waitcnt lgkmcnt(3)
    v_add_u32_sdwa v220, v162, v220 dst_sel:DWORD dst_unused:UNUSED_PAD src0_sel:WORD_0 src1_sel:DWORD
    v_lshlrev_b32 v199, 14, v162
    v_and_or_b32 v212, v199, s71, v212
    v_cmp_lt_u32_sdwa vcc, v220, v162 src0_sel:DWORD src1_sel:WORD_1
    s_nop 0
    s_mov_b64 exec, vcc
    ds_write_b32 v220, v212 offset:0
    v_xor_b32 v250, 4, v250
    s_mov_b64 s[50:51], exec
    s_mov_b64 exec, s[48:49]
    s_waitcnt lgkmcnt(3)
    v_add_u32_sdwa v221, v163, v221 dst_sel:DWORD dst_unused:UNUSED_PAD src0_sel:WORD_0 src1_sel:DWORD
    v_lshlrev_b32 v199, 14, v163
    v_and_or_b32 v213, v199, s71, v213
    v_cmp_lt_u32_sdwa vcc, v221, v163 src0_sel:DWORD src1_sel:WORD_1
    s_nop 0
    s_mov_b64 exec, vcc
    ds_write_b32 v221, v213 offset:0
    v_xor_b32 v250, 8, v250
    s_mov_b64 s[52:53], exec
    s_mov_b64 exec, -1
    s_mov_b64 s[58:59], 0
    s_cmp_eq_u64 s[56:57], 0
    s_cbranch_scc0 L_p2_rare
L_p2_done:
    v_and_b32 v199, 0xff, v250
    v_cmp_ne_u32 vcc, 0, v199
    s_nop 0
    s_or_b64 s[58:59], s[58:59], vcc
    s_cbranch_scc0 L_nomore
    v_mov_b32 v198, 0
    v_mov_b32 v199, 1
    ds_write_b32 v198, v199 offset:23616
L_nomore:
    s_waitcnt lgkmcnt(0)
    s_barrier
    s_mov_b32 s63, 0
    s_waitcnt vmcnt(0)
    s_mov_b64 exec, s[72:73]
    v_lshlrev_b32 v198, 1, v218
    ds_write_b64 v198, v[176:177] offset:4096
    s_mov_b64 exec, s[74:75]
    v_lshlrev_b32 v198, 1, v219
    ds_write_b64 v198, v[178:179] offset:4096
    s_mov_b64 exec, s[50:51]
    v_lshlrev_b32 v198, 1, v220
    ds_write_b64 v198, v[180:181] offset:4096
    s_mov_b64 exec, s[52:53]
    v_lshlrev_b32 v198, 1, v221
    ds_write_b64 v198, v[182:183] offset:4096
    s_mov_b64 exec, -1
    s_cmp_lt_u32 s3, 4
    s_cbranch_scc1 L_follow1
    s_setprio 1
    ds_read_u16 v234, v242 offset:0
    ds_read_u16 v236, v242 offset:32
    s_cmp_lt_u32 s63, s31
    s_cselect_b32 s10, 25000, 0
    s_cselect_b32 s14, 25000, 0
    s_add_u32 m0, s34, 10112
    s_lshr_b32 s64, s43, 1
    s_lshl_b32 s64, s64, 2
    s_and_b32 s65, s43, 1
    s_or_b32 s64, s64, s65
    s_lshr_b32 s65, s62, 1
    s_lshl_b32 s65, s65, 2
    s_and_b32 s66, s62, 1
    s_or_b32 s65, s65, s66
    s_lshl_b32 s64, s64, 12
    s_lshl_b32 s65, s65, 12
    s_mov_b32 vcc_lo, 0
    v_add_u32 v160, s64, v254
    v_add_u32 v161, s65, v254
    s_mov_b32 vcc_hi, -1
    s_lshl_b32 s67, s3, 9
    v_cndmask_b32 v160, v160, v161, vcc
    v_mov_b32 v206, 0
    v_lshl_add_u32 v204, v249, 2, s67
    v_xor_b32 v161, 32, v160
    v_xor_b32 v162, 64, v160
    v_xor_b32 v163, 96, v160
    ds_read_b32 v207, v206 offset:23616
    ds_read_b32 v228, v204 offset:0
    ds_read_b32 v229, v204 offset:256
    ds_read_b64_tr_b16 v[168:169], v160 offset:0
    ds_read_b64_tr_b16 v[170:171], v161 offset:0
    ds_read_b64_tr_b16 v[172:173], v162 offset:0
    ds_read_b64_tr_b16 v[174:175], v163 offset:0
    ds_read_b64_tr_b16 v[176:177], v160 offset:1024
    s_waitcnt lgkmcnt(9)
    buffer_load_dwordx4 v[234:235], s[8:11], 0 idxen offen offset:128 lds
    s_add_u32 m0, s34, 12032
    s_add_u32 s63, s63, 1
    v_add_u32 v242, 64, v242
    s_mov_b32 s32, 1
    ds_read_b64_tr_b16 v[178:179], v161 offset:1024
    ds_read_b64_tr_b16 v[180:181], v162 offset:1024
    ds_read_b64_tr_b16 v[182:183], v163 offset:1024
    ds_read_b64_tr_b16 v[184:185], v160 offset:2048
    ds_read_b64_tr_b16 v[186:187], v161 offset:2048
    ds_read_b64_tr_b16 v[188:189], v162 offset:2048
    ds_read_b64_tr_b16 v[190:191], v163 offset:2048
    ds_read_b64_tr_b16 v[192:193], v160 offset:3072
    buffer_load_dwordx4 v[234:235], s[8:11], 0 idxen offen offset:256 lds
    s_add_u32 m0, s34, 13952
    s_waitcnt lgkmcnt(14)
    v_readfirstlane_b32 s54, v207
    ds_read_b64_tr_b16 v[194:195], v161 offset:3072
    ds_read_b64_tr_b16 v[196:197], v162 offset:3072
    ds_read_b64_tr_b16 v[198:199], v163 offset:3072
    buffer_load_dwordx4 v[234:235], s[8:11], 0 idxen offen offset:384 lds
    s_add_u32 m0, s34, 8192
    s_nop 0
    buffer_load_dwordx4 v[234:235], s[12:15], 0 idxen offen lds
    s_add_u32 m0, s34, 11136
    s_nop 0
    buffer_load_dwordx4 v[236:237], s[8:11], 0 idxen offen offset:128 lds
    s_add_u32 m0, s34, 13056
    s_nop 0
    buffer_load_dwordx4 v[236:237], s[8:11], 0 idxen offen offset:256 lds
    s_add_u32 m0, s34, 14976
    s_nop 0
    buffer_load_dwordx4 v[236:237], s[8:11], 0 idxen offen offset:384 lds
    s_add_u32 m0, s34, 9216
    s_lshl_b32 s64, s3, 10
    v_lshl_add_u32 v205, v249, 3, s64
    buffer_load_dwordx4 v[236:237], s[12:15], 0 idxen offen lds
    s_waitcnt lgkmcnt(0)
    s_branch L_lead1
L_follow1:
    s_lshr_b32 s64, s43, 1
    s_lshl_b32 s64, s64, 2
    s_and_b32 s65, s43, 1
    s_or_b32 s64, s64, s65
    s_lshr_b32 s65, s62, 1
    s_lshl_b32 s65, s65, 2
    s_and_b32 s66, s62, 1
    s_or_b32 s65, s65, s66
    s_lshl_b32 s64, s64, 12
    s_lshl_b32 s65, s65, 12
    s_mov_b32 vcc_lo, 0
    v_add_u32 v160, s64, v254
    v_add_u32 v161, s65, v254
    s_mov_b32 vcc_hi, -1
    s_lshl_b32 s67, s3, 9
    v_cndmask_b32 v160, v160, v161, vcc
    v_mov_b32 v206, 0
    v_lshl_add_u32 v204, v249, 2, s67
    v_xor_b32 v161, 32, v160
    v_xor_b32 v162, 64, v160
    v_xor_b32 v163, 96, v160
    ds_read_b32 v207, v206 offset:23616
    ds_read_b32 v228, v204 offset:0
    ds_read_b32 v229, v204 offset:256
    ds_read_b64_tr_b16 v[168:169], v160 offset:0
    ds_read_b64_tr_b16 v[170:171], v161 offset:0
    ds_read_b64_tr_b16 v[172:173], v162 offset:0
    ds_read_b64_tr_b16 v[174:175], v163 offset:0
    ds_read_b64_tr_b16 v[176:177], v160 offset:1024
    s_lshl_b32 s64, s3, 10
    v_lshl_add_u32 v205, v249, 3, s64
    s_mov_b32 s32, 1
    ds_read_b64_tr_b16 v[178:179], v161 offset:1024
    ds_read_b64_tr_b16 v[180:181], v162 offset:1024
    ds_read_b64_tr_b16 v[182:183], v163 offset:1024
    ds_read_b64_tr_b16 v[184:185], v160 offset:2048
    ds_read_b64_tr_b16 v[186:187], v161 offset:2048
    ds_read_b64_tr_b16 v[188:189], v162 offset:2048
    ds_read_b64_tr_b16 v[190:191], v163 offset:2048
    ds_read_b64_tr_b16 v[192:193], v160 offset:3072
    s_waitcnt lgkmcnt(14)
    v_readfirstlane_b32 s54, v207
    ds_read_b64_tr_b16 v[194:195], v161 offset:3072
    ds_read_b64_tr_b16 v[196:197], v162 offset:3072
    ds_read_b64_tr_b16 v[198:199], v163 offset:3072
    s_waitcnt lgkmcnt(0)
L_lead1:
    s_barrier
    ds_read_b64 v[230:231], v205 offset:4096
    ds_read_b64 v[232:233], v205 offset:4608
    s_cmp_eq_u32 s55, 0
    s_cbranch_scc1 L_nores
    v_mfma_f32_16x16x16_bf16 v[0:3], v[168:169], v[252:253], 0
    v_mfma_f32_16x16x16_bf16 v[4:7], v[170:171], v[252:253], 0
    v_mfma_f32_16x16x16_bf16 v[8:11], v[172:173], v[252:253], 0
    v_mfma_f32_16x16x16_bf16 v[12:15], v[174:175], v[252:253], 0
    v_mfma_f32_16x16x16_bf16 v[16:19], v[176:177], v[252:253], 0
    v_mfma_f32_16x16x16_bf16 v[20:23], v[178:179], v[252:253], 0
    v_mfma_f32_16x16x16_bf16 v[24:27], v[180:181], v[252:253], 0
    v_mfma_f32_16x16x16_bf16 v[28:31], v[182:183], v[252:253], 0
    v_mfma_f32_16x16x16_bf16 v[32:35], v[184:185], v[252:253], 0
    v_mfma_f32_16x16x16_bf16 v[36:39], v[186:187], v[252:253], 0
    v_mfma_f32_16x16x16_bf16 v[40:43], v[188:189], v[252:253], 0
    v_mfma_f32_16x16x16_bf16 v[44:47], v[190:191], v[252:253], 0
    v_mfma_f32_16x16x16_bf16 v[48:51], v[192:193], v[252:253], 0
    v_mfma_f32_16x16x16_bf16 v[52:55], v[194:195], v[252:253], 0
    v_mfma_f32_16x16x16_bf16 v[56:59], v[196:197], v[252:253], 0
    v_mfma_f32_16x16x16_bf16 v[60:63], v[198:199], v[252:253], 0
L_nores:
    s_cmp_ge_u32 s3, 4
    s_cbranch_scc1 L_lead2
    ds_read_u16 v234, v242 offset:0
    ds_read_u16 v236, v242 offset:32
    s_cmp_lt_u32 s63, s31
    s_cselect_b32 s10, 25000, 0
    s_cselect_b32 s14, 25000, 0
    s_add_u32 m0, s34, 10112
    s_add_u32 s63, s63, 1
    v_add_u32 v242, 64, v242
    s_waitcnt lgkmcnt(1)
    buffer_load_dwordx4 v[234:235], s[8:11], 0 idxen offen offset:128 lds
    s_add_u32 m0, s34, 12032
    s_nop 0
    buffer_load_dwordx4 v[234:235], s[8:11], 0 idxen offen offset:256 lds
    s_add_u32 m0, s34, 13952
    s_nop 0
    buffer_load_dwordx4 v[234:235], s[8:11], 0 idxen offen offset:384 lds
    s_add_u32 m0, s34, 8192
    s_nop 0
    buffer_load_dwordx4 v[234:235], s[12:15], 0 idxen offen lds
    s_add_u32 m0, s34, 11136
    s_nop 0
    s_waitcnt lgkmcnt(0)
    buffer_load_dwordx4 v[236:237], s[8:11], 0 idxen offen offset:128 lds
    s_add_u32 m0, s34, 13056
    s_nop 0
    buffer_load_dwordx4 v[236:237], s[8:11], 0 idxen offen offset:256 lds
    s_add_u32 m0, s34, 14976
    s_nop 0
    buffer_load_dwordx4 v[236:237], s[8:11], 0 idxen offen offset:384 lds
    s_add_u32 m0, s34, 9216
    s_nop 0
    buffer_load_dwordx4 v[236:237], s[12:15], 0 idxen offen lds
L_lead2:
    s_waitcnt lgkmcnt(0)
    s_cmp_eq_u32 s31, 0
    s_cbranch_scc1 L_loop_done
    s_movk_i32 s70, 23680
    s_cmp_gt_u32 s30, 64
    s_cbranch_scc1 L_geo2
    v_bfe_u32 v167, v228, 16, 7
    v_lshlrev_b32 v166, 4, v167
    v_mad_u32_u24 v167, v167, 6, s70
    v_and_b32 v167, -4, v167
    ds_read2_b32 v[178:179], v167 offset0:0 offset1:1
    v_lshlrev_b32 v168, 4, v228
    v_alignbit_b32 v230, v231, v230, v168
    v_lshlrev_b32 v160, 16, v230
    v_and_b32 v161, 0xffff0000, v230
    v_lshrrev_b32 v231, v168, v231
    v_lshlrev_b32 v162, 16, v231
    s_lshl_b32 s64, s3, 10
    s_lshl_b32 s65, s3, 8
    s_sub_u32 s66, s30, 0
    s_waitcnt lgkmcnt(0)
    v_alignbit_b32 v178, v179, v178, v166
    v_lshlrev_b32 v163, 16, v178
    v_and_b32 v164, 0xffff0000, v178
    v_lshrrev_b32 v179, v166, v179
    v_sub_f32 v160, v160, v163
    v_sub_f32 v161, v161, v164
    v_lshlrev_b32 v165, 16, v179
    v_cvt_pk_bf16_f32 v161, v160, v161
    v_sub_f32 v162, v162, v165
    v_lshlrev_b32 v160, 16, v161
    v_and_b32 v161, 0xffff0000, v161
    v_cvt_pk_bf16_f32 v162, v162, v162
    v_mul_f32 v163, v160, v160
    v_mul_f32 v164, v161, v161
    v_and_b32 v162, 0xffff0000, v162
    v_cvt_pk_bf16_f32 v164, v163, v164
    v_mul_f32 v165, v162, v162
    v_lshlrev_b32 v163, 16, v164
    v_cvt_pk_bf16_f32 v165, v165, v165
    v_and_b32 v164, 0xffff0000, v164
    v_and_b32 v165, 0xffff0000, v165
    v_add_f32 v163, v163, v164
    v_add_f32 v163, v163, v165
    v_cvt_pk_bf16_f32 v163, v163, v163
    v_and_b32 v163, 0xffff0000, v163
    v_add_f32 v163, 0x322bcc77, v163
    v_cvt_pk_bf16_f32 v163, v163, v163
    v_and_b32 v163, 0xffff0000, v163
    v_sqrt_f32 v163, v163
    v_lshl_add_u32 v164, v249, 1, s65
    v_cvt_pk_bf16_f32 v163, v163, v163
    v_and_b32 v170, 0xffff0000, v163
    v_mul_f32 v172, 0x40490fdb, v170
    v_cvt_pk_bf16_f32 v172, v172, v172
    v_and_b32 v172, 0xffff0000, v172
    v_mul_f32 v174, s38, v170
    v_mul_f32 v175, s39, v170
    v_mul_f32 v176, s40, v170
    v_mul_f32 v177, s41, v170
    v_mul_f32 v172, 0x3e4ccccd, v172
    v_cvt_pk_bf16_f32 v175, v174, v175
    v_cvt_pk_bf16_f32 v177, v176, v177
    v_cvt_pk_bf16_f32 v172, v172, v172
    v_lshlrev_b32 v174, 16, v175
    v_lshlrev_b32 v176, 16, v177
    v_and_b32 v172, 0xffff0000, v172
    v_and_b32 v175, 0xffff0000, v175
    v_and_b32 v177, 0xffff0000, v177
    v_mul_f32 v172, 0.15915494, v172
    v_mul_f32 v174, 0.15915494, v174
    v_mul_f32 v175, 0.15915494, v175
    v_mul_f32 v176, 0.15915494, v176
    v_mul_f32 v177, 0.15915494, v177
    v_cos_f32 v172, v172
    v_fract_f32 v174, v174
    v_fract_f32 v175, v175
    v_fract_f32 v176, v176
    v_fract_f32 v177, v177
    v_sin_f32 v174, v174
    v_sin_f32 v175, v175
    v_sin_f32 v176, v176
    v_sin_f32 v177, v177
    v_cvt_pk_bf16_f32 v172, v172, v172
    v_rcp_f32 v171, v170
    v_and_b32 v172, 0xffff0000, v172
    v_cvt_pk_bf16_f32 v175, v174, v175
    v_cvt_pk_bf16_f32 v177, v176, v177
    v_add_f32 v172, 1.0, v172
    v_lshlrev_b32 v174, 16, v175
    v_lshlrev_b32 v176, 16, v177
    v_and_b32 v175, 0xffff0000, v175
    v_and_b32 v177, 0xffff0000, v177
    v_cvt_pk_bf16_f32 v172, v172, v172
    v_mul_f32 v174, v174, v171
    v_mul_f32 v175, v175, v171
    v_mul_f32 v176, v176, v171
    v_mul_f32 v177, v177, v171
    v_and_b32 v172, 0xffff0000, v172
    v_cvt_pk_bf16_f32 v175, v174, v175
    v_cvt_pk_bf16_f32 v177, v176, v177
    v_mul_f32 v172, 0.5, v172
    v_mul_f32 v169, 0, v170
    v_cmp_gt_f32 vcc, 0x40a00000, v170
    v_lshlrev_b32 v174, 16, v175
    v_lshlrev_b32 v176, 16, v177
    v_cndmask_b32 v172, v169, v172, vcc
    v_and_b32 v175, 0xffff0000, v175
    v_and_b32 v177, 0xffff0000, v177
    v_mul_f32 v160, v160, v171
    v_mul_f32 v161, v161, v171
    v_mul_f32 v162, v162, v171
    v_mul_f32 v174, v174, v172
    v_mul_f32 v175, v175, v172
    v_mul_f32 v176, v176, v172
    v_mul_f32 v177, v177, v172
    v_cmp_gt_u32 vcc, s66, v249
    v_cvt_pk_bf16_f32 v182, v160, v161
    v_cvt_pk_bf16_f32 v183, v162, v162
    v_cvt_pk_bf16_f32 v180, v174, v175
    v_cvt_pk_bf16_f32 v181, v176, v177
    v_lshl_add_u32 v163, v249, 3, s64
    s_mov_b64 exec, vcc
    ds_write_b16 v164, v182 offset:12288
    ds_write_b16_d16_hi v164, v182 offset:14336
    ds_write_b64 v163, v[180:181] offset:4096
    ds_write_b16 v164, v183 offset:16384
    s_mov_b64 exec, -1
    s_branch L_geo_done
L_geo2:
    v_bfe_u32 v167, v228, 16, 7
    v_lshlrev_b32 v166, 4, v167
    v_mad_u32_u24 v167, v167, 6, s70
    v_bfe_u32 v201, v229, 16, 7
    v_and_b32 v167, -4, v167
    v_lshlrev_b32 v200, 4, v201
    v_mad_u32_u24 v201, v201, 6, s70
    ds_read2_b32 v[178:179], v167 offset0:0 offset1:1
    v_and_b32 v201, -4, v201
    ds_read2_b32 v[212:213], v201 offset0:0 offset1:1
    v_lshlrev_b32 v168, 4, v228
    v_alignbit_b32 v230, v231, v230, v168
    v_lshlrev_b32 v202, 4, v229
    v_lshlrev_b32 v160, 16, v230
    v_and_b32 v161, 0xffff0000, v230
    v_alignbit_b32 v232, v233, v232, v202
    v_lshrrev_b32 v231, v168, v231
    v_lshlrev_b32 v194, 16, v232
    v_and_b32 v195, 0xffff0000, v232
    v_lshlrev_b32 v162, 16, v231
    v_lshrrev_b32 v233, v202, v233
    v_lshlrev_b32 v196, 16, v233
    s_sub_u32 s66, s30, 0
    s_lshl_b32 s64, s3, 10
    s_lshl_b32 s65, s3, 8
    s_waitcnt lgkmcnt(1)
    v_alignbit_b32 v178, v179, v178, v166
    v_lshlrev_b32 v163, 16, v178
    v_and_b32 v164, 0xffff0000, v178
    s_waitcnt lgkmcnt(0)
    v_alignbit_b32 v212, v213, v212, v200
    v_lshrrev_b32 v179, v166, v179
    v_sub_f32 v160, v160, v163
    v_sub_f32 v161, v161, v164
    v_lshlrev_b32 v197, 16, v212
    v_and_b32 v198, 0xffff0000, v212
    v_lshlrev_b32 v165, 16, v179
    v_cvt_pk_bf16_f32 v161, v160, v161
    v_lshrrev_b32 v213, v200, v213
    v_sub_f32 v194, v194, v197
    v_sub_f32 v195, v195, v198
    v_sub_f32 v162, v162, v165
    v_lshlrev_b32 v160, 16, v161
    v_and_b32 v161, 0xffff0000, v161
    v_lshlrev_b32 v199, 16, v213
    v_cvt_pk_bf16_f32 v195, v194, v195
    v_cvt_pk_bf16_f32 v162, v162, v162
    v_mul_f32 v163, v160, v160
    v_mul_f32 v164, v161, v161
    v_sub_f32 v196, v196, v199
    v_lshlrev_b32 v194, 16, v195
    v_and_b32 v162, 0xffff0000, v162
    v_and_b32 v195, 0xffff0000, v195
    v_cvt_pk_bf16_f32 v164, v163, v164
    v_cvt_pk_bf16_f32 v196, v196, v196
    v_mul_f32 v165, v162, v162
    v_mul_f32 v197, v194, v194
    v_mul_f32 v198, v195, v195
    v_lshlrev_b32 v163, 16, v164
    v_and_b32 v196, 0xffff0000, v196
    v_cvt_pk_bf16_f32 v165, v165, v165
    v_and_b32 v164, 0xffff0000, v164
    v_cvt_pk_bf16_f32 v198, v197, v198
    v_mul_f32 v199, v196, v196
    v_and_b32 v165, 0xffff0000, v165
    v_add_f32 v163, v163, v164
    v_lshlrev_b32 v197, 16, v198
    v_cvt_pk_bf16_f32 v199, v199, v199
    v_and_b32 v198, 0xffff0000, v198
    v_add_f32 v163, v163, v165
    v_and_b32 v199, 0xffff0000, v199
    v_add_f32 v197, v197, v198
    v_cvt_pk_bf16_f32 v163, v163, v163
    v_add_f32 v197, v197, v199
    v_and_b32 v163, 0xffff0000, v163
    v_cvt_pk_bf16_f32 v197, v197, v197
    v_add_f32 v163, 0x322bcc77, v163
    v_and_b32 v197, 0xffff0000, v197
    v_cvt_pk_bf16_f32 v163, v163, v163
    v_add_f32 v197, 0x322bcc77, v197
    v_and_b32 v163, 0xffff0000, v163
    v_cvt_pk_bf16_f32 v197, v197, v197
    v_sqrt_f32 v163, v163
    v_and_b32 v197, 0xffff0000, v197
    v_sqrt_f32 v197, v197
    v_cvt_pk_bf16_f32 v163, v163, v163
    v_and_b32 v170, 0xffff0000, v163
    v_cvt_pk_bf16_f32 v197, v197, v197
    v_mul_f32 v172, 0x40490fdb, v170
    v_and_b32 v204, 0xffff0000, v197
    v_cvt_pk_bf16_f32 v172, v172, v172
    v_mul_f32 v206, 0x40490fdb, v204
    v_and_b32 v172, 0xffff0000, v172
    v_cvt_pk_bf16_f32 v206, v206, v206
    v_mul_f32 v172, 0x3e4ccccd, v172
    v_and_b32 v206, 0xffff0000, v206
    v_cvt_pk_bf16_f32 v172, v172, v172
    v_mul_f32 v174, s38, v170
    v_mul_f32 v175, s39, v170
    v_mul_f32 v176, s40, v170
    v_mul_f32 v177, s41, v170
    v_mul_f32 v208, s38, v204
    v_mul_f32 v209, s39, v204
    v_mul_f32 v210, s40, v204
    v_mul_f32 v211, s41, v204
    v_mul_f32 v206, 0x3e4ccccd, v206
    v_and_b32 v172, 0xffff0000, v172
    v_cvt_pk_bf16_f32 v175, v174, v175
    v_cvt_pk_bf16_f32 v177, v176, v177
    v_cvt_pk_bf16_f32 v209, v208, v209
    v_cvt_pk_bf16_f32 v211, v210, v211
    v_cvt_pk_bf16_f32 v206, v206, v206
    v_mul_f32 v172, 0.15915494, v172
    v_lshlrev_b32 v174, 16, v175
    v_lshlrev_b32 v176, 16, v177
    v_lshlrev_b32 v208, 16, v209
    v_lshlrev_b32 v210, 16, v211
    v_and_b32 v175, 0xffff0000, v175
    v_and_b32 v177, 0xffff0000, v177
    v_and_b32 v206, 0xffff0000, v206
    v_and_b32 v209, 0xffff0000, v209
    v_and_b32 v211, 0xffff0000, v211
    v_cos_f32 v172, v172
    v_mul_f32 v174, 0.15915494, v174
    v_mul_f32 v175, 0.15915494, v175
    v_mul_f32 v176, 0.15915494, v176
    v_mul_f32 v177, 0.15915494, v177
    v_mul_f32 v206, 0.15915494, v206
    v_mul_f32 v208, 0.15915494, v208
    v_mul_f32 v209, 0.15915494, v209
    v_mul_f32 v210, 0.15915494, v210
    v_mul_f32 v211, 0.15915494, v211
    v_fract_f32 v174, v174
    v_fract_f32 v175, v175
    v_fract_f32 v176, v176
    v_fract_f32 v177, v177
    v_cos_f32 v206, v206
    v_fract_f32 v208, v208
    v_fract_f32 v209, v209
    v_fract_f32 v210, v210
    v_fract_f32 v211, v211
    v_cvt_pk_bf16_f32 v172, v172, v172
    v_sin_f32 v174, v174
    v_sin_f32 v175, v175
    v_sin_f32 v176, v176
    v_sin_f32 v177, v177
    v_sin_f32 v208, v208
    v_sin_f32 v209, v209
    v_sin_f32 v210, v210
    v_sin_f32 v211, v211
    v_and_b32 v172, 0xffff0000, v172
    v_cvt_pk_bf16_f32 v206, v206, v206
    v_add_f32 v172, 1.0, v172
    v_rcp_f32 v171, v170
    v_cvt_pk_bf16_f32 v175, v174, v175
    v_cvt_pk_bf16_f32 v177, v176, v177
    v_rcp_f32 v205, v204
    v_and_b32 v206, 0xffff0000, v206
    v_cvt_pk_bf16_f32 v209, v208, v209
    v_cvt_pk_bf16_f32 v211, v210, v211
    v_cvt_pk_bf16_f32 v172, v172, v172
    v_lshlrev_b32 v174, 16, v175
    v_lshlrev_b32 v176, 16, v177
    v_add_f32 v206, 1.0, v206
    v_lshlrev_b32 v208, 16, v209
    v_lshlrev_b32 v210, 16, v211
    v_and_b32 v172, 0xffff0000, v172
    v_and_b32 v175, 0xffff0000, v175
    v_and_b32 v177, 0xffff0000, v177
    v_and_b32 v209, 0xffff0000, v209
    v_and_b32 v211, 0xffff0000, v211
    v_cvt_pk_bf16_f32 v206, v206, v206
    v_mul_f32 v172, 0.5, v172
    v_mul_f32 v169, 0, v170
    v_cmp_gt_f32 vcc, 0x40a00000, v170
    v_mul_f32 v174, v174, v171
    v_mul_f32 v175, v175, v171
    v_mul_f32 v176, v176, v171
    v_mul_f32 v177, v177, v171
    v_mul_f32 v208, v208, v205
    v_mul_f32 v209, v209, v205
    v_mul_f32 v210, v210, v205
    v_mul_f32 v211, v211, v205
    v_and_b32 v206, 0xffff0000, v206
    v_cndmask_b32 v172, v169, v172, vcc
    v_cvt_pk_bf16_f32 v175, v174, v175
    v_cvt_pk_bf16_f32 v177, v176, v177
    v_cvt_pk_bf16_f32 v209, v208, v209
    v_cvt_pk_bf16_f32 v211, v210, v211
    v_mul_f32 v206, 0.5, v206
    v_mul_f32 v203, 0, v204
    v_cmp_gt_f32 vcc, 0x40a00000, v204
    v_lshlrev_b32 v174, 16, v175
    v_lshlrev_b32 v176, 16, v177
    v_lshlrev_b32 v208, 16, v209
    v_lshlrev_b32 v210, 16, v211
    v_and_b32 v175, 0xffff0000, v175
    v_and_b32 v177, 0xffff0000, v177
    v_cndmask_b32 v206, v203, v206, vcc
    v_and_b32 v209, 0xffff0000, v209
    v_and_b32 v211, 0xffff0000, v211
    v_mul_f32 v160, v160, v171
    v_mul_f32 v161, v161, v171
    v_mul_f32 v162, v162, v171
    v_mul_f32 v174, v174, v172
    v_mul_f32 v175, v175, v172
    v_mul_f32 v176, v176, v172
    v_mul_f32 v177, v177, v172
    v_mul_f32 v194, v194, v205
    v_mul_f32 v195, v195, v205
    v_mul_f32 v196, v196, v205
    v_mul_f32 v208, v208, v206
    v_mul_f32 v209, v209, v206
    v_mul_f32 v210, v210, v206
    v_mul_f32 v211, v211, v206
    v_cmp_gt_u32 vcc, s66, v249
    v_cvt_pk_bf16_f32 v182, v160, v161
    v_cvt_pk_bf16_f32 v183, v162, v162
    v_cvt_pk_bf16_f32 v180, v174, v175
    v_cvt_pk_bf16_f32 v181, v176, v177
    v_cvt_pk_bf16_f32 v216, v194, v195
    v_cvt_pk_bf16_f32 v217, v196, v196
    v_cvt_pk_bf16_f32 v214, v208, v209
    v_cvt_pk_bf16_f32 v215, v210, v211
    v_lshl_add_u32 v163, v249, 3, s64
    v_lshl_add_u32 v164, v249, 1, s65
    s_mov_b64 exec, vcc
    ds_write_b16 v164, v182 offset:12288
    ds_write_b16_d16_hi v164, v182 offset:14336
    ds_write_b64 v163, v[180:181] offset:4096
    ds_write_b16 v164, v183 offset:16384
    s_mov_b64 exec, -1
    s_sub_u32 s66, s30, 64
    v_cmp_gt_u32 vcc, s66, v249
    s_nop 0
    s_mov_b64 exec, vcc
    ds_write_b16 v164, v216 offset:12416
    ds_write_b16_d16_hi v164, v216 offset:14464
    ds_write_b64 v163, v[214:215] offset:4608
    ds_write_b16 v164, v217 offset:16512
    s_mov_b64 exec, -1
L_geo_done:
    ds_read_b32 v238, v239 offset:0
    ds_read_b64 v[168:169], v241 offset:0
    ds_read_b64_tr_b16 v[170:171], v248 offset:256
    ds_read_b64_tr_b16 v[172:173], v248 offset:128
    s_waitcnt lgkmcnt(3)
    v_add_u32_sdwa v238, v238, v247 dst_sel:DWORD dst_unused:UNUSED_PAD src0_sel:BYTE_3 src1_sel:DWORD
    ds_read_b64_tr_b16 v[174:175], v238
L_loop:
    s_cmp_le_i32 s32, s35
    s_cbranch_scc1 L_pr0
    s_setprio 0
L_pr0:
    s_waitcnt vmcnt(0) lgkmcnt(0)
    ds_read_u16 v234, v242 offset:0
    ds_read_u16 v236, v242 offset:32
    ds_read_b128 v[160:163], v245 offset:8192
    ds_read_b128 v[164:167], v245 offset:8256
    ds_read_u16_d16_hi v210, v243 offset:10240
    ds_read_u16_d16_hi v211, v243 offset:10368
    ds_read_u16_d16_hi v212, v243 offset:10496
    ds_read_u16_d16_hi v213, v243 offset:10624
    s_cmp_lt_u32 s63, s31
    s_cselect_b32 s10, 25000, 0
    s_cselect_b32 s14, 25000, 0
    s_add_u32 m0, s34, 1920
    v_mfma_f32_4x4x4_16b_bf16 v[202:205], v[168:169], v[170:171], 0
    v_and_b32 v178, 0x3f803f80, v174
    v_mfma_f32_4x4x4_16b_bf16 v[206:209], v[168:169], v[172:173], 0
    v_and_b32 v179, 0x3f803f80, v175
    v_and_b32 v182, 0x3f803f80, v174
    v_and_b32 v183, 0x3f803f80, v175
    s_add_u32 s32, s32, 1
    s_add_u32 s63, s63, 1
    s_waitcnt lgkmcnt(7)
    buffer_load_dwordx4 v[234:235], s[8:11], 0 idxen offen offset:128 lds
    s_add_u32 m0, s34, 3840
    ds_read_b64_tr_b16 v[170:171], v248 offset:0
    ds_read_b64_tr_b16 v[172:173], v248 offset:288
    ds_read_u16_d16_hi v214, v243 offset:12288
    ds_read_u16_d16_hi v215, v243 offset:12416
    ds_read_u16_d16_hi v216, v243 offset:12544
    ds_read_u16_d16_hi v217, v243 offset:12672
    ds_read_u16_d16_hi v218, v243 offset:14336
    ds_read_u16_d16_hi v219, v243 offset:14464
    s_waitcnt lgkmcnt(13)
    v_mfma_f32_16x16x32_bf16 v[194:197], v[160:163], v[80:83], 0
    v_mfma_f32_16x16x32_bf16 v[198:201], v[160:163], v[72:75], 0
    s_waitcnt lgkmcnt(12)
    v_mfma_f32_16x16x32_bf16 v[194:197], v[164:167], v[84:87], v[194:197]
    buffer_load_dwordx4 v[234:235], s[8:11], 0 idxen offen offset:256 lds
    s_add_u32 m0, s34, 5760
    v_mfma_f32_16x16x32_bf16 v[198:201], v[164:167], v[76:79], v[198:201]
    ds_read_u16_d16_hi v220, v243 offset:14592
    ds_read_u16_d16_hi v221, v243 offset:14720
    ds_read_b64 v[180:181], v240 offset:0
    ds_read_b64 v[176:177], v240 offset:2048
    ds_read_b64 v[184:185], v240 offset:4096
    ds_read_u16_d16_hi v222, v244 offset:10240
    ds_read_u16_d16_hi v223, v244 offset:10368
    ds_read_u16_d16_hi v224, v244 offset:10496
    v_mul_f32 v194, v194, v202
    v_mul_f32 v195, v195, v203
    v_mul_f32 v196, v196, v204
    v_mul_f32 v197, v197, v205
    buffer_load_dwordx4 v[234:235], s[8:11], 0 idxen offen offset:384 lds
    s_add_u32 m0, s34, 0
    v_mul_f32 v198, v198, v206
    v_mul_f32 v199, v199, v207
    v_mul_f32 v200, v200, v208
    v_mul_f32 v201, v201, v209
    s_waitcnt lgkmcnt(14)
    v_mfma_f32_4x4x4_16b_bf16 v[202:205], v[168:169], v[170:171], 0
    v_cvt_pk_bf16_f32 v188, v194, v195
    v_mfma_f32_4x4x4_16b_bf16 v[206:209], v[168:169], v[172:173], 0
    v_cvt_pk_bf16_f32 v189, v196, v197
    v_mul_f32 v210, v210, v198
    v_mul_f32 v211, v211, v199
    v_mul_f32 v212, v212, v200
    v_mul_f32 v213, v213, v201
    s_waitcnt lgkmcnt(13)
    v_mul_f32 v214, v214, v198
    s_waitcnt lgkmcnt(12)
    v_mul_f32 v215, v215, v199
    ds_read_b64_tr_b16 v[170:171], v248 offset:160
    ds_read_b64_tr_b16 v[172:173], v248 offset:32
    ds_read_u16_d16_hi v225, v244 offset:10624
    ds_read_u16_d16_hi v226, v244 offset:12288
    ds_read_u16_d16_hi v227, v244 offset:12416
    ds_read_u16_d16_hi v228, v244 offset:12544
    ds_read_u16_d16_hi v229, v244 offset:12672
    ds_read_u16_d16_hi v230, v244 offset:14336
    buffer_load_dwordx4 v[234:235], s[12:15], 0 idxen offen lds
    s_add_u32 m0, s34, 2944
    s_waitcnt lgkmcnt(14)
    v_mul_f32 v216, v216, v200
    v_mul_f32 v217, v217, v201
    v_mul_f32 v218, v218, v198
    v_mul_f32 v219, v219, v199
    v_mul_f32 v220, v220, v200
    v_mul_f32 v221, v221, v201
    v_mfma_f32_16x16x32_bf16 v[194:197], v[160:163], v[64:67], 0
    s_waitcnt lgkmcnt(13)
    v_and_b32 v180, v180, v174
    v_and_b32 v181, v181, v175
    v_mfma_f32_16x16x32_bf16 v[198:201], v[160:163], v[104:107], 0
    v_cvt_pk_bf16_f32 v186, v210, v211
    v_cvt_pk_bf16_f32 v187, v212, v213
    s_waitcnt lgkmcnt(12)
    v_and_b32 v176, v176, v174
    v_mfma_f32_16x16x32_bf16 v[194:197], v[164:167], v[68:71], v[194:197]
    v_and_b32 v177, v177, v175
    buffer_load_dwordx4 v[236:237], s[8:11], 0 idxen offen offset:128 lds
    s_add_u32 m0, s34, 4864
    v_mfma_f32_16x16x32_bf16 v[198:201], v[164:167], v[108:111], v[198:201]
    s_waitcnt lgkmcnt(11)
    v_and_b32 v184, v184, v174
    v_and_b32 v185, v185, v175
    v_mfma_f32_16x16x32_bf16 v[16:19], v[186:189], v[178:181], v[16:19]
    v_cvt_pk_bf16_f32 v190, v214, v215
    v_mul_f32 v194, v194, v202
    v_mul_f32 v195, v195, v203
    v_mul_f32 v196, v196, v204
    v_mul_f32 v197, v197, v205
    v_mul_f32 v198, v198, v206
    v_mul_f32 v199, v199, v207
    v_mul_f32 v200, v200, v208
    v_mul_f32 v201, v201, v209
    s_waitcnt lgkmcnt(7)
    v_mfma_f32_4x4x4_16b_bf16 v[202:205], v[168:169], v[170:171], 0
    ds_read_b64_tr_b16 v[170:171], v248 offset:320
    ds_read_u16_d16_hi v231, v244 offset:14464
    ds_read_u16_d16_hi v232, v244 offset:14592
    ds_read_u16_d16_hi v233, v244 offset:14720
    ds_read_u16_d16_hi v210, v243 offset:10304
    ds_read_u16_d16_hi v211, v243 offset:10432
    ds_read_u16_d16_hi v212, v243 offset:10560
    ds_read_u16_d16_hi v213, v243 offset:10688
    buffer_load_dwordx4 v[236:237], s[8:11], 0 idxen offen offset:256 lds
    s_add_u32 m0, s34, 6784
    s_waitcnt lgkmcnt(14)
    v_mfma_f32_4x4x4_16b_bf16 v[206:209], v[168:169], v[172:173], 0
    v_cvt_pk_bf16_f32 v191, v216, v217
    v_cvt_pk_bf16_f32 v186, v218, v219
    v_cvt_pk_bf16_f32 v187, v220, v221
    v_mfma_f32_16x16x32_bf16 v[32:35], v[188:191], v[176:179], v[32:35]
    v_cvt_pk_bf16_f32 v192, v194, v195
    v_cvt_pk_bf16_f32 v193, v196, v197
    v_mfma_f32_16x16x32_bf16 v[48:51], v[186:189], v[182:185], v[48:51]
    v_cvt_pk_bf16_f32 v188, v198, v199
    v_cvt_pk_bf16_f32 v189, v200, v201
    v_mfma_f32_16x16x32_bf16 v[194:197], v[160:163], v[96:99], 0
    v_mfma_f32_16x16x32_bf16 v[198:201], v[160:163], v[88:91], 0
    buffer_load_dwordx4 v[236:237], s[8:11], 0 idxen offen offset:384 lds
    s_add_u32 m0, s34, 1024
    ds_read_b64_tr_b16 v[172:173], v248 offset:192
    ds_read_u16_d16_hi v214, v243 offset:12352
    ds_read_u16_d16_hi v215, v243 offset:12480
    ds_read_u16_d16_hi v216, v243 offset:12608
    ds_read_u16_d16_hi v217, v243 offset:12736
    ds_read_u16_d16_hi v218, v243 offset:14400
    ds_read_u16_d16_hi v219, v243 offset:14528
    ds_read_u16_d16_hi v220, v243 offset:14656
    v_mfma_f32_16x16x32_bf16 v[194:197], v[164:167], v[100:103], v[194:197]
    s_cmp_le_u32 s32, s31
    v_mfma_f32_16x16x32_bf16 v[198:201], v[164:167], v[92:95], v[198:201]
    v_mfma_f32_16x16x16_bf16 v[0:3], v[192:193], v[178:179], v[0:3]
    buffer_load_dwordx4 v[236:237], s[12:15], 0 idxen offen lds
    s_nop 3
    v_mul_f32 v194, v194, v202
    v_mul_f32 v195, v195, v203
    v_mul_f32 v196, v196, v204
    v_mul_f32 v197, v197, v205
    v_mul_f32 v198, v198, v206
    v_mul_f32 v199, v199, v207
    v_mul_f32 v200, v200, v208
    v_mul_f32 v201, v201, v209
    s_waitcnt lgkmcnt(14)
    v_mfma_f32_4x4x4_16b_bf16 v[202:205], v[168:169], v[170:171], 0
    ds_read_b64_tr_b16 v[170:171], v248 offset:64
    ds_read_u16_d16_hi v221, v243 offset:14784
    ds_read_b32 v238, v239 offset:64
    ds_read_b64 v[252:253], v241 offset:128
    s_waitcnt lgkmcnt(11)
    v_mfma_f32_4x4x4_16b_bf16 v[206:209], v[168:169], v[172:173], 0
    ds_read_b64_tr_b16 v[172:173], v248 offset:352
    v_mul_f32 v222, v222, v194
    v_mul_f32 v223, v223, v195
    v_mul_f32 v224, v224, v196
    v_mul_f32 v225, v225, v197
    v_mul_f32 v226, v226, v194
    v_mul_f32 v227, v227, v195
    v_mul_f32 v228, v228, v196
    v_mul_f32 v229, v229, v197
    v_mul_f32 v230, v230, v194
    v_mul_f32 v231, v231, v195
    v_mul_f32 v232, v232, v196
    v_mul_f32 v233, v233, v197
    v_mfma_f32_16x16x32_bf16 v[194:197], v[160:163], v[128:131], 0
    v_cvt_pk_bf16_f32 v192, v198, v199
    v_cvt_pk_bf16_f32 v193, v200, v201
    v_mfma_f32_16x16x32_bf16 v[198:201], v[160:163], v[120:123], 0
    v_cvt_pk_bf16_f32 v186, v222, v223
    v_cvt_pk_bf16_f32 v187, v224, v225
    v_cvt_pk_bf16_f32 v190, v226, v227
    v_mfma_f32_16x16x32_bf16 v[194:197], v[164:167], v[132:135], v[194:197]
    v_cvt_pk_bf16_f32 v191, v228, v229
    ds_read_u16_d16_hi v222, v244 offset:10304
    ds_read_u16_d16_hi v223, v244 offset:10432
    ds_read_u16_d16_hi v224, v244 offset:10560
    ds_read_u16_d16_hi v225, v244 offset:10688
    ds_read_u16_d16_hi v226, v244 offset:12352
    ds_read_u16_d16_hi v227, v244 offset:12480
    ds_read_u16_d16_hi v228, v244 offset:12608
    ds_read_u16_d16_hi v229, v244 offset:12736
    v_mfma_f32_16x16x32_bf16 v[198:201], v[164:167], v[124:127], v[198:201]
    v_mul_f32 v194, v194, v202
    v_mul_f32 v195, v195, v203
    v_mfma_f32_16x16x32_bf16 v[20:23], v[186:189], v[178:181], v[20:23]
    v_cvt_pk_bf16_f32 v186, v230, v231
    v_cvt_pk_bf16_f32 v187, v232, v233
    v_mfma_f32_16x16x32_bf16 v[36:39], v[188:191], v[176:179], v[36:39]
    v_mul_f32 v196, v196, v204
    v_mul_f32 v197, v197, v205
    v_mfma_f32_16x16x32_bf16 v[52:55], v[186:189], v[182:185], v[52:55]
    v_cvt_pk_bf16_f32 v188, v194, v195
    v_cvt_pk_bf16_f32 v189, v196, v197
    v_mul_f32 v198, v198, v206
    v_mul_f32 v199, v199, v207
    v_mul_f32 v200, v200, v208
    v_mul_f32 v201, v201, v209
    v_mfma_f32_16x16x32_bf16 v[194:197], v[160:163], v[112:115], 0
    v_mul_f32 v210, v210, v198
    v_mul_f32 v211, v211, v199
    s_waitcnt lgkmcnt(12)
    v_mfma_f32_4x4x4_16b_bf16 v[202:205], v[168:169], v[170:171], 0
    ds_read_b64_tr_b16 v[170:171], v248 offset:224
    ds_read_u16_d16_hi v230, v244 offset:14400
    ds_read_u16_d16_hi v231, v244 offset:14528
    ds_read_u16_d16_hi v232, v244 offset:14656
    ds_read_u16_d16_hi v233, v244 offset:14784
    s_waitcnt lgkmcnt(13)
    v_mfma_f32_4x4x4_16b_bf16 v[206:209], v[168:169], v[172:173], 0
    ds_read_b64_tr_b16 v[172:173], v248 offset:96
    v_mul_f32 v212, v212, v200
    v_mul_f32 v213, v213, v201
    v_mul_f32 v214, v214, v198
    v_mul_f32 v215, v215, v199
    v_mul_f32 v216, v216, v200
    v_mul_f32 v217, v217, v201
    v_mul_f32 v218, v218, v198
    v_mul_f32 v219, v219, v199
    v_mul_f32 v220, v220, v200
    v_mul_f32 v221, v221, v201
    v_mfma_f32_16x16x32_bf16 v[198:201], v[160:163], v[152:155], 0
    v_cvt_pk_bf16_f32 v186, v210, v211
    v_cvt_pk_bf16_f32 v187, v212, v213
    v_mfma_f32_16x16x32_bf16 v[194:197], v[164:167], v[116:119], v[194:197]
    v_cvt_pk_bf16_f32 v190, v214, v215
    v_cvt_pk_bf16_f32 v191, v216, v217
    v_mfma_f32_16x16x16_bf16 v[4:7], v[192:193], v[178:179], v[4:7]
    v_add_u32_sdwa v238, v238, v247 dst_sel:DWORD dst_unused:UNUSED_PAD src0_sel:BYTE_3 src1_sel:DWORD
    ds_read_b64_tr_b16 v[174:175], v238
    v_mfma_f32_16x16x32_bf16 v[198:201], v[164:167], v[156:159], v[198:201]
    s_nop 1
    v_mul_f32 v194, v194, v202
    v_mul_f32 v195, v195, v203
    v_mul_f32 v196, v196, v204
    v_mul_f32 v197, v197, v205
    v_cvt_pk_bf16_f32 v192, v194, v195
    v_cvt_pk_bf16_f32 v193, v196, v197
    v_mfma_f32_16x16x32_bf16 v[24:27], v[186:189], v[178:181], v[24:27]
    v_cvt_pk_bf16_f32 v186, v218, v219
    v_cvt_pk_bf16_f32 v187, v220, v221
    v_mfma_f32_16x16x32_bf16 v[194:197], v[160:163], v[144:147], 0
    v_mul_f32 v198, v198, v206
    v_mul_f32 v199, v199, v207
    v_mul_f32 v200, v200, v208
    v_mul_f32 v201, v201, v209
    v_mfma_f32_16x16x32_bf16 v[40:43], v[188:191], v[176:179], v[40:43]
    v_mfma_f32_16x16x32_bf16 v[56:59], v[186:189], v[182:185], v[56:59]
    v_cvt_pk_bf16_f32 v188, v198, v199
    v_cvt_pk_bf16_f32 v189, v200, v201
    s_waitcnt lgkmcnt(6)
    v_mfma_f32_4x4x4_16b_bf16 v[202:205], v[168:169], v[170:171], 0
    ds_read_b64_tr_b16 v[170:171], v248 offset:256
    s_waitcnt lgkmcnt(2)
    v_mfma_f32_4x4x4_16b_bf16 v[206:209], v[168:169], v[172:173], 0
    ds_read_b64_tr_b16 v[172:173], v248 offset:128
    v_mfma_f32_16x16x32_bf16 v[198:201], v[160:163], v[136:139], 0
    v_mfma_f32_16x16x32_bf16 v[194:197], v[164:167], v[148:151], v[194:197]
    v_mfma_f32_16x16x16_bf16 v[8:11], v[192:193], v[178:179], v[8:11]
    v_mfma_f32_16x16x32_bf16 v[198:201], v[164:167], v[140:143], v[198:201]
    s_nop 5
    v_mul_f32 v194, v194, v202
    v_mul_f32 v195, v195, v203
    v_mul_f32 v196, v196, v204
    v_mul_f32 v197, v197, v205
    v_mul_f32 v222, v222, v194
    v_mul_f32 v223, v223, v195
    v_mul_f32 v224, v224, v196
    v_mul_f32 v225, v225, v197
    v_cvt_pk_bf16_f32 v186, v222, v223
    v_cvt_pk_bf16_f32 v187, v224, v225
    v_mul_f32 v226, v226, v194
    v_mul_f32 v227, v227, v195
    v_mfma_f32_16x16x32_bf16 v[28:31], v[186:189], v[178:181], v[28:31]
    v_mul_f32 v228, v228, v196
    v_mul_f32 v229, v229, v197
    v_mul_f32 v230, v230, v194
    v_mul_f32 v231, v231, v195
    v_mul_f32 v232, v232, v196
    v_mul_f32 v233, v233, v197
    v_mul_f32 v198, v198, v206
    v_mul_f32 v199, v199, v207
    v_mul_f32 v200, v200, v208
    v_mul_f32 v201, v201, v209
    v_cvt_pk_bf16_f32 v190, v226, v227
    v_cvt_pk_bf16_f32 v191, v228, v229
    v_cvt_pk_bf16_f32 v186, v230, v231
    v_cvt_pk_bf16_f32 v187, v232, v233
    v_cvt_pk_bf16_f32 v192, v198, v199
    v_cvt_pk_bf16_f32 v193, v200, v201
    v_mfma_f32_16x16x32_bf16 v[44:47], v[188:191], v[176:179], v[44:47]
    v_mfma_f32_16x16x32_bf16 v[60:63], v[186:189], v[182:185], v[60:63]
    v_mfma_f32_16x16x16_bf16 v[12:15], v[192:193], v[178:179], v[12:15]
    s_cbranch_scc0 L_loop_done
    s_cmp_le_i32 s32, s35
    s_cbranch_scc1 L_pr1
    s_setprio 0
L_pr1:
    s_waitcnt vmcnt(0) lgkmcnt(0)
    ds_read_u16 v234, v242 offset:64
    ds_read_u16 v236, v242 offset:96
    ds_read_b128 v[160:163], v245 offset:0
    ds_read_b128 v[164:167], v245 offset:64
    ds_read_u16_d16_hi v210, v243 offset:2048
    ds_read_u16_d16_hi v211, v243 offset:2176
    ds_read_u16_d16_hi v212, v243 offset:2304
    ds_read_u16_d16_hi v213, v243 offset:2432
    s_cmp_lt_u32 s63, s31
    s_cselect_b32 s10, 25000, 0
    s_cselect_b32 s14, 25000, 0
    s_add_u32 m0, s34, 10112
    v_mfma_f32_4x4x4_16b_bf16 v[202:205], v[252:253], v[170:171], 0
    v_and_b32 v178, 0x3f803f80, v174
    v_mfma_f32_4x4x4_16b_bf16 v[206:209], v[252:253], v[172:173], 0
    v_and_b32 v179, 0x3f803f80, v175
    v_and_b32 v182, 0x3f803f80, v174
    v_and_b32 v183, 0x3f803f80, v175
    v_add_u32 v239, 0x80, v239
    v_add_u32 v241, 0x100, v241
    s_add_u32 s32, s32, 1
    s_add_u32 s63, s63, 1
    v_add_u32 v242, 128, v242
    s_waitcnt lgkmcnt(7)
    buffer_load_dwordx4 v[234:235], s[8:11], 0 idxen offen offset:128 lds
    s_add_u32 m0, s34, 12032
    ds_read_b64_tr_b16 v[170:171], v248 offset:0
    ds_read_b64_tr_b16 v[172:173], v248 offset:288
    ds_read_u16_d16_hi v214, v243 offset:4096
    ds_read_u16_d16_hi v215, v243 offset:4224
    ds_read_u16_d16_hi v216, v243 offset:4352
    ds_read_u16_d16_hi v217, v243 offset:4480
    ds_read_u16_d16_hi v218, v243 offset:6144
    ds_read_u16_d16_hi v219, v243 offset:6272
    s_waitcnt lgkmcnt(13)
    v_mfma_f32_16x16x32_bf16 v[194:197], v[160:163], v[80:83], 0
    v_mfma_f32_16x16x32_bf16 v[198:201], v[160:163], v[72:75], 0
    s_waitcnt lgkmcnt(12)
    v_mfma_f32_16x16x32_bf16 v[194:197], v[164:167], v[84:87], v[194:197]
    buffer_load_dwordx4 v[234:235], s[8:11], 0 idxen offen offset:256 lds
    s_add_u32 m0, s34, 13952
    v_mfma_f32_16x16x32_bf16 v[198:201], v[164:167], v[76:79], v[198:201]
    ds_read_u16_d16_hi v220, v243 offset:6400
    ds_read_u16_d16_hi v221, v243 offset:6528
    ds_read_b64 v[180:181], v240 offset:32
    ds_read_b64 v[176:177], v240 offset:2080
    ds_read_b64 v[184:185], v240 offset:4128
    ds_read_u16_d16_hi v222, v244 offset:2048
    ds_read_u16_d16_hi v223, v244 offset:2176
    ds_read_u16_d16_hi v224, v244 offset:2304
    v_mul_f32 v194, v194, v202
    v_mul_f32 v195, v195, v203
    v_mul_f32 v196, v196, v204
    v_mul_f32 v197, v197, v205
    buffer_load_dwordx4 v[234:235], s[8:11], 0 idxen offen offset:384 lds
    s_add_u32 m0, s34, 8192
    v_mul_f32 v198, v198, v206
    v_mul_f32 v199, v199, v207
    v_mul_f32 v200, v200, v208
    v_mul_f32 v201, v201, v209
    s_waitcnt lgkmcnt(14)
    v_mfma_f32_4x4x4_16b_bf16 v[202:205], v[252:253], v[170:171], 0
    v_cvt_pk_bf16_f32 v188, v194, v195
    v_mfma_f32_4x4x4_16b_bf16 v[206:209], v[252:253], v[172:173], 0
    v_cvt_pk_bf16_f32 v189, v196, v197
    v_mul_f32 v210, v210, v198
    v_mul_f32 v211, v211, v199
    v_mul_f32 v212, v212, v200
    v_mul_f32 v213, v213, v201
    s_waitcnt lgkmcnt(13)
    v_mul_f32 v214, v214, v198
    s_waitcnt lgkmcnt(12)
    v_mul_f32 v215, v215, v199
    ds_read_b64_tr_b16 v[170:171], v248 offset:160
    ds_read_b64_tr_b16 v[172:173], v248 offset:32
    ds_read_u16_d16_hi v225, v244 offset:2432
    ds_read_u16_d16_hi v226, v244 offset:4096
    ds_read_u16_d16_hi v227, v244 offset:4224
    ds_read_u16_d16_hi v228, v244 offset:4352
    ds_read_u16_d16_hi v229, v244 offset:4480
    ds_read_u16_d16_hi v230, v244 offset:6144
    buffer_load_dwordx4 v[234:235], s[12:15], 0 idxen offen lds
    s_add_u32 m0, s34, 11136
    s_waitcnt lgkmcnt(14)
    v_mul_f32 v216, v216, v200
    v_mul_f32 v217, v217, v201
    v_mul_f32 v218, v218, v198
    v_mul_f32 v219, v219, v199
    v_mul_f32 v220, v220, v200
    v_mul_f32 v221, v221, v201
    v_mfma_f32_16x16x32_bf16 v[194:197], v[160:163], v[64:67], 0
    s_waitcnt lgkmcnt(13)
    v_and_b32 v180, v180, v174
    v_and_b32 v181, v181, v175
    v_mfma_f32_16x16x32_bf16 v[198:201], v[160:163], v[104:107], 0
    v_cvt_pk_bf16_f32 v186, v210, v211
    v_cvt_pk_bf16_f32 v187, v212, v213
    s_waitcnt lgkmcnt(12)
    v_and_b32 v176, v176, v174
    v_mfma_f32_16x16x32_bf16 v[194:197], v[164:167], v[68:71], v[194:197]
    v_and_b32 v177, v177, v175
    buffer_load_dwordx4 v[236:237], s[8:11], 0 idxen offen offset:128 lds
    s_add_u32 m0, s34, 13056
    v_mfma_f32_16x16x32_bf16 v[198:201], v[164:167], v[108:111], v[198:201]
    s_waitcnt lgkmcnt(11)
    v_and_b32 v184, v184, v174
    v_and_b32 v185, v185, v175
    v_mfma_f32_16x16x32_bf16 v[16:19], v[186:189], v[178:181], v[16:19]
    v_cvt_pk_bf16_f32 v190, v214, v215
    v_mul_f32 v194, v194, v202
    v_mul_f32 v195, v195, v203
    v_mul_f32 v196, v196, v204
    v_mul_f32 v197, v197, v205
    v_mul_f32 v198, v198, v206
    v_mul_f32 v199, v199, v207
    v_mul_f32 v200, v200, v208
    v_mul_f32 v201, v201, v209
    s_waitcnt lgkmcnt(7)
    v_mfma_f32_4x4x4_16b_bf16 v[202:205], v[252:253], v[170:171], 0
    ds_read_b64_tr_b16 v[170:171], v248 offset:320
    ds_read_u16_d16_hi v231, v244 offset:6272
    ds_read_u16_d16_hi v232, v244 offset:6400
    ds_read_u16_d16_hi v233, v244 offset:6528
    ds_read_u16_d16_hi v210, v243 offset:2112
    ds_read_u16_d16_hi v211, v243 offset:2240
    ds_read_u16_d16_hi v212, v243 offset:2368
    ds_read_u16_d16_hi v213, v243 offset:2496
    buffer_load_dwordx4 v[236:237], s[8:11], 0 idxen offen offset:256 lds
    s_add_u32 m0, s34, 14976
    s_waitcnt lgkmcnt(14)
    v_mfma_f32_4x4x4_16b_bf16 v[206:209], v[252:253], v[172:173], 0
    v_cvt_pk_bf16_f32 v191, v216, v217
    v_cvt_pk_bf16_f32 v186, v218, v219
    v_cvt_pk_bf16_f32 v187, v220, v221
    v_mfma_f32_16x16x32_bf16 v[32:35], v[188:191], v[176:179], v[32:35]
    v_cvt_pk_bf16_f32 v192, v194, v195
    v_cvt_pk_bf16_f32 v193, v196, v197
    v_mfma_f32_16x16x32_bf16 v[48:51], v[186:189], v[182:185], v[48:51]
    v_cvt_pk_bf16_f32 v188, v198, v199
    v_cvt_pk_bf16_f32 v189, v200, v201
    v_mfma_f32_16x16x32_bf16 v[194:197], v[160:163], v[96:99], 0
    v_add_u32 v240, 64, v240
    v_mfma_f32_16x16x32_bf16 v[198:201], v[160:163], v[88:91], 0
    buffer_load_dwordx4 v[236:237], s[8:11], 0 idxen offen offset:384 lds
    s_add_u32 m0, s34, 9216
    ds_read_b64_tr_b16 v[172:173], v248 offset:192
    ds_read_u16_d16_hi v214, v243 offset:4160
    ds_read_u16_d16_hi v215, v243 offset:4288
    ds_read_u16_d16_hi v216, v243 offset:4416
    ds_read_u16_d16_hi v217, v243 offset:4544
    ds_read_u16_d16_hi v218, v243 offset:6208
    ds_read_u16_d16_hi v219, v243 offset:6336
    ds_read_u16_d16_hi v220, v243 offset:6464
    v_mfma_f32_16x16x32_bf16 v[194:197], v[164:167], v[100:103], v[194:197]
    s_cmp_le_u32 s32, s31
    v_mfma_f32_16x16x32_bf16 v[198:201], v[164:167], v[92:95], v[198:201]
    v_mfma_f32_16x16x16_bf16 v[0:3], v[192:193], v[178:179], v[0:3]
    buffer_load_dwordx4 v[236:237], s[12:15], 0 idxen offen lds
    s_nop 3
    v_mul_f32 v194, v194, v202
    v_mul_f32 v195, v195, v203
    v_mul_f32 v196, v196, v204
    v_mul_f32 v197, v197, v205
    v_mul_f32 v198, v198, v206
    v_mul_f32 v199, v199, v207
    v_mul_f32 v200, v200, v208
    v_mul_f32 v201, v201, v209
    s_waitcnt lgkmcnt(14)
    v_mfma_f32_4x4x4_16b_bf16 v[202:205], v[252:253], v[170:171], 0
    ds_read_b64_tr_b16 v[170:171], v248 offset:64
    ds_read_u16_d16_hi v221, v243 offset:6592
    ds_read_b32 v238, v239 offset:0
    ds_read_b64 v[168:169], v241 offset:0
    s_waitcnt lgkmcnt(11)
    v_mfma_f32_4x4x4_16b_bf16 v[206:209], v[252:253], v[172:173], 0
    ds_read_b64_tr_b16 v[172:173], v248 offset:352
    v_mul_f32 v222, v222, v194
    v_mul_f32 v223, v223, v195
    v_mul_f32 v224, v224, v196
    v_mul_f32 v225, v225, v197
    v_mul_f32 v226, v226, v194
    v_mul_f32 v227, v227, v195
    v_mul_f32 v228, v228, v196
    v_mul_f32 v229, v229, v197
    v_mul_f32 v230, v230, v194
    v_mul_f32 v231, v231, v195
    v_mul_f32 v232, v232, v196
    v_mul_f32 v233, v233, v197
    v_mfma_f32_16x16x32_bf16 v[194:197], v[160:163], v[128:131], 0
    v_cvt_pk_bf16_f32 v192, v198, v199
    v_cvt_pk_bf16_f32 v193, v200, v201
    v_mfma_f32_16x16x32_bf16 v[198:201], v[160:163], v[120:123], 0
    v_cvt_pk_bf16_f32 v186, v222, v223
    v_cvt_pk_bf16_f32 v187, v224, v225
    v_cvt_pk_bf16_f32 v190, v226, v227
    v_mfma_f32_16x16x32_bf16 v[194:197], v[164:167], v[132:135], v[194:197]
    v_cvt_pk_bf16_f32 v191, v228, v229
    ds_read_u16_d16_hi v222, v244 offset:2112
    ds_read_u16_d16_hi v223, v244 offset:2240
    ds_read_u16_d16_hi v224, v244 offset:2368
    ds_read_u16_d16_hi v225, v244 offset:2496
    ds_read_u16_d16_hi v226, v244 offset:4160
    ds_read_u16_d16_hi v227, v244 offset:4288
    ds_read_u16_d16_hi v228, v244 offset:4416
    ds_read_u16_d16_hi v229, v244 offset:4544
    v_mfma_f32_16x16x32_bf16 v[198:201], v[164:167], v[124:127], v[198:201]
    v_mul_f32 v194, v194, v202
    v_mul_f32 v195, v195, v203
    v_mfma_f32_16x16x32_bf16 v[20:23], v[186:189], v[178:181], v[20:23]
    v_cvt_pk_bf16_f32 v186, v230, v231
    v_cvt_pk_bf16_f32 v187, v232, v233
    v_mfma_f32_16x16x32_bf16 v[36:39], v[188:191], v[176:179], v[36:39]
    v_mul_f32 v196, v196, v204
    v_mul_f32 v197, v197, v205
    v_mfma_f32_16x16x32_bf16 v[52:55], v[186:189], v[182:185], v[52:55]
    v_cvt_pk_bf16_f32 v188, v194, v195
    v_cvt_pk_bf16_f32 v189, v196, v197
    v_mul_f32 v198, v198, v206
    v_mul_f32 v199, v199, v207
    v_mul_f32 v200, v200, v208
    v_mul_f32 v201, v201, v209
    v_mfma_f32_16x16x32_bf16 v[194:197], v[160:163], v[112:115], 0
    v_mul_f32 v210, v210, v198
    v_mul_f32 v211, v211, v199
    s_waitcnt lgkmcnt(12)
    v_mfma_f32_4x4x4_16b_bf16 v[202:205], v[252:253], v[170:171], 0
    ds_read_b64_tr_b16 v[170:171], v248 offset:224
    ds_read_u16_d16_hi v230, v244 offset:6208
    ds_read_u16_d16_hi v231, v244 offset:6336
    ds_read_u16_d16_hi v232, v244 offset:6464
    ds_read_u16_d16_hi v233, v244 offset:6592
    s_waitcnt lgkmcnt(13)
    v_mfma_f32_4x4x4_16b_bf16 v[206:209], v[252:253], v[172:173], 0
    ds_read_b64_tr_b16 v[172:173], v248 offset:96
    v_mul_f32 v212, v212, v200
    v_mul_f32 v213, v213, v201
    v_mul_f32 v214, v214, v198
    v_mul_f32 v215, v215, v199
    v_mul_f32 v216, v216, v200
    v_mul_f32 v217, v217, v201
    v_mul_f32 v218, v218, v198
    v_mul_f32 v219, v219, v199
    v_mul_f32 v220, v220, v200
    v_mul_f32 v221, v221, v201
    v_mfma_f32_16x16x32_bf16 v[198:201], v[160:163], v[152:155], 0
    v_cvt_pk_bf16_f32 v186, v210, v211
    v_cvt_pk_bf16_f32 v187, v212, v213
    v_mfma_f32_16x16x32_bf16 v[194:197], v[164:167], v[116:119], v[194:197]
    v_cvt_pk_bf16_f32 v190, v214, v215
    v_cvt_pk_bf16_f32 v191, v216, v217
    v_mfma_f32_16x16x16_bf16 v[4:7], v[192:193], v[178:179], v[4:7]
    v_add_u32_sdwa v238, v238, v247 dst_sel:DWORD dst_unused:UNUSED_PAD src0_sel:BYTE_3 src1_sel:DWORD
    ds_read_b64_tr_b16 v[174:175], v238
    v_mfma_f32_16x16x32_bf16 v[198:201], v[164:167], v[156:159], v[198:201]
    s_nop 1
    v_mul_f32 v194, v194, v202
    v_mul_f32 v195, v195, v203
    v_mul_f32 v196, v196, v204
    v_mul_f32 v197, v197, v205
    v_cvt_pk_bf16_f32 v192, v194, v195
    v_cvt_pk_bf16_f32 v193, v196, v197
    v_mfma_f32_16x16x32_bf16 v[24:27], v[186:189], v[178:181], v[24:27]
    v_cvt_pk_bf16_f32 v186, v218, v219
    v_cvt_pk_bf16_f32 v187, v220, v221
    v_mfma_f32_16x16x32_bf16 v[194:197], v[160:163], v[144:147], 0
    v_mul_f32 v198, v198, v206
    v_mul_f32 v199, v199, v207
    v_mul_f32 v200, v200, v208
    v_mul_f32 v201, v201, v209
    v_mfma_f32_16x16x32_bf16 v[40:43], v[188:191], v[176:179], v[40:43]
    v_mfma_f32_16x16x32_bf16 v[56:59], v[186:189], v[182:185], v[56:59]
    v_cvt_pk_bf16_f32 v188, v198, v199
    v_cvt_pk_bf16_f32 v189, v200, v201
    s_waitcnt lgkmcnt(6)
    v_mfma_f32_4x4x4_16b_bf16 v[202:205], v[252:253], v[170:171], 0
    ds_read_b64_tr_b16 v[170:171], v248 offset:256
    s_waitcnt lgkmcnt(2)
    v_mfma_f32_4x4x4_16b_bf16 v[206:209], v[252:253], v[172:173], 0
    ds_read_b64_tr_b16 v[172:173], v248 offset:128
    v_mfma_f32_16x16x32_bf16 v[198:201], v[160:163], v[136:139], 0
    v_mfma_f32_16x16x32_bf16 v[194:197], v[164:167], v[148:151], v[194:197]
    v_mfma_f32_16x16x16_bf16 v[8:11], v[192:193], v[178:179], v[8:11]
    v_mfma_f32_16x16x32_bf16 v[198:201], v[164:167], v[140:143], v[198:201]
    s_nop 5
    v_mul_f32 v194, v194, v202
    v_mul_f32 v195, v195, v203
    v_mul_f32 v196, v196, v204
    v_mul_f32 v197, v197, v205
    v_mul_f32 v222, v222, v194
    v_mul_f32 v223, v223, v195
    v_mul_f32 v224, v224, v196
    v_mul_f32 v225, v225, v197
    v_cvt_pk_bf16_f32 v186, v222, v223
    v_cvt_pk_bf16_f32 v187, v224, v225
    v_mul_f32 v226, v226, v194
    v_mul_f32 v227, v227, v195
    v_mfma_f32_16x16x32_bf16 v[28:31], v[186:189], v[178:181], v[28:31]
    v_mul_f32 v228, v228, v196
    v_mul_f32 v229, v229, v197
    v_mul_f32 v230, v230, v194
    v_mul_f32 v231, v231, v195
    v_mul_f32 v232, v232, v196
    v_mul_f32 v233, v233, v197
    v_mul_f32 v198, v198, v206
    v_mul_f32 v199, v199, v207
    v_mul_f32 v200, v200, v208
    v_mul_f32 v201, v201, v209
    v_cvt_pk_bf16_f32 v190, v226, v227
    v_cvt_pk_bf16_f32 v191, v228, v229
    v_cvt_pk_bf16_f32 v186, v230, v231
    v_cvt_pk_bf16_f32 v187, v232, v233
    v_cvt_pk_bf16_f32 v192, v198, v199
    v_cvt_pk_bf16_f32 v193, v200, v201
    v_mfma_f32_16x16x32_bf16 v[44:47], v[188:191], v[176:179], v[44:47]
    v_mfma_f32_16x16x32_bf16 v[60:63], v[186:189], v[182:185], v[60:63]
    v_mfma_f32_16x16x16_bf16 v[12:15], v[192:193], v[178:179], v[12:15]
    s_cbranch_scc1 L_loop
L_loop_done:
    s_setprio 0
    s_cmp_lg_u32 s54, 0
    s_cbranch_scc1 L_again
    s_waitcnt vmcnt(0) lgkmcnt(0)
    v_and_b32 v64, 15, v249
    v_lshrrev_b32 v80, 5, v249
    v_xor_b32 v80, v80, v64
    v_lshlrev_b32 v80, 4, v80
    v_lshl_add_u32 v80, v64, 9, v80
    v_bfe_u32 v81, v249, 4, 1
    v_lshl_add_u32 v80, v81, 3, v80
    v_add_u32 v72, s34, v80
    v_cvt_pk_bf16_f32 v128, v0, v1
    v_cvt_pk_bf16_f32 v129, v2, v3
    v_xor_b32 v73, 32, v72
    v_cvt_pk_bf16_f32 v130, v4, v5
    v_cvt_pk_bf16_f32 v131, v6, v7
    v_xor_b32 v74, 64, v72
    ds_write_b64 v72, v[128:129] offset:0
    ds_write_b64 v73, v[130:131] offset:0
    v_cvt_pk_bf16_f32 v132, v8, v9
    v_cvt_pk_bf16_f32 v133, v10, v11
    v_xor_b32 v75, 96, v72
    v_cvt_pk_bf16_f32 v134, v12, v13
    v_cvt_pk_bf16_f32 v135, v14, v15
    v_xor_b32 v76, 128, v72
    ds_write_b64 v74, v[132:133] offset:0
    ds_write_b64 v75, v[134:135] offset:0
    v_cvt_pk_bf16_f32 v136, v16, v17
    v_cvt_pk_bf16_f32 v137, v18, v19
    v_xor_b32 v77, 160, v72
    v_cvt_pk_bf16_f32 v138, v20, v21
    v_cvt_pk_bf16_f32 v139, v22, v23
    v_xor_b32 v78, 192, v72
    ds_write_b64 v76, v[136:137] offset:0
    ds_write_b64 v77, v[138:139] offset:0
    v_cvt_pk_bf16_f32 v140, v24, v25
    v_cvt_pk_bf16_f32 v141, v26, v27
    v_xor_b32 v79, 224, v72
    v_cvt_pk_bf16_f32 v142, v28, v29
    v_cvt_pk_bf16_f32 v143, v30, v31
    ds_write_b64 v78, v[140:141] offset:0
    ds_write_b64 v79, v[142:143] offset:0
    v_cvt_pk_bf16_f32 v144, v32, v33
    v_cvt_pk_bf16_f32 v145, v34, v35
    v_lshrrev_b32 v160, 5, v249
    v_and_b32 v161, 31, v249
    v_cvt_pk_bf16_f32 v146, v36, v37
    v_cvt_pk_bf16_f32 v147, v38, v39
    ds_write_b64 v72, v[144:145] offset:256
    ds_write_b64 v73, v[146:147] offset:256
    v_cvt_pk_bf16_f32 v148, v40, v41
    v_cvt_pk_bf16_f32 v149, v42, v43
    v_xor_b32 v162, v161, v160
    v_cvt_pk_bf16_f32 v150, v44, v45
    v_cvt_pk_bf16_f32 v151, v46, v47
    ds_write_b64 v74, v[148:149] offset:256
    ds_write_b64 v75, v[150:151] offset:256
    v_cvt_pk_bf16_f32 v152, v48, v49
    v_cvt_pk_bf16_f32 v153, v50, v51
    v_lshlrev_b32 v162, 4, v162
    v_cvt_pk_bf16_f32 v154, v52, v53
    v_cvt_pk_bf16_f32 v155, v54, v55
    ds_write_b64 v76, v[152:153] offset:256
    ds_write_b64 v77, v[154:155] offset:256
    v_cvt_pk_bf16_f32 v156, v56, v57
    v_cvt_pk_bf16_f32 v157, v58, v59
    v_lshl_add_u32 v162, v160, 9, v162
    v_cvt_pk_bf16_f32 v158, v60, v61
    v_cvt_pk_bf16_f32 v159, v62, v63
    ds_write_b64 v78, v[156:157] offset:256
    ds_write_b64 v79, v[158:159] offset:256
    v_add_u32 v162, s34, v162
    v_xor_b32 v164, 0, v162
    v_xor_b32 v165, 32, v162
    v_xor_b32 v166, 64, v162
    v_xor_b32 v168, 128, v162
    ds_read_b128 v[176:179], v164 offset:0
    v_xor_b32 v169, 160, v162
    ds_read_b128 v[180:183], v165 offset:1024
    v_xor_b32 v170, 192, v162
    v_xor_b32 v167, 96, v162
    v_xor_b32 v171, 224, v162
    v_lshlrev_b32 v161, 4, v161
    ds_read_b128 v[184:187], v166 offset:2048
    s_add_u32 s66, s29, s43
    ds_read_b128 v[192:195], v168 offset:4096
    v_lshl_add_u32 v161, v160, 13, v161
    s_lshl_b32 s66, s66, 9
    s_add_u32 s67, s29, s62
    s_lshl_b32 s67, s67, 9
    ds_read_b128 v[196:199], v169 offset:5120
    ds_read_b128 v[200:203], v170 offset:6144
    ds_read_b128 v[188:191], v167 offset:3072
    ds_read_b128 v[204:207], v171 offset:7168
    s_waitcnt lgkmcnt(7)
    buffer_store_dwordx4 v[176:179], v161, s[20:23], s66 offen sc1
    s_add_u32 s66, s66, 16384
    s_waitcnt lgkmcnt(6)
    buffer_store_dwordx4 v[180:183], v161, s[20:23], s66 offen sc1
    s_add_u32 s66, s66, 16384
    s_waitcnt lgkmcnt(5)
    buffer_store_dwordx4 v[184:187], v161, s[20:23], s66 offen sc1
    s_add_u32 s66, s66, 16384
    s_waitcnt lgkmcnt(4)
    buffer_store_dwordx4 v[192:195], v161, s[20:23], s67 offen sc1
    s_add_u32 s67, s67, 16384
    s_waitcnt lgkmcnt(3)
    buffer_store_dwordx4 v[196:199], v161, s[20:23], s67 offen sc1
    s_add_u32 s67, s67, 16384
    s_waitcnt lgkmcnt(2)
    buffer_store_dwordx4 v[200:203], v161, s[20:23], s67 offen sc1
    s_add_u32 s67, s67, 16384
    s_mov_b32 exec_hi, 0
    s_cmp_gt_u32 s43, 1
    s_waitcnt lgkmcnt(0)
    s_cbranch_scc1 L_noa6
    buffer_store_dwordx4 v[188:191], v161, s[20:23], s66 offen sc1
L_noa6:
    s_cmp_gt_u32 s62, 1
    s_cbranch_scc1 L_nob6
    buffer_store_dwordx4 v[204:207], v161, s[20:23], s67 offen sc1
L_nob6:
    s_or_b32 s64, s2, s3
    s_cmp_lg_u32 s64, 0
    s_cbranch_scc1 L_fin
    s_mov_b64 exec, 1
    v_mov_b32 v1, 11468800
    v_mov_b32 v2, s42
    buffer_store_dword v2, v1, s[16:19], 0 offen
L_fin:
L_end:
    s_endpgm
L_again:
    s_waitcnt vmcnt(0) lgkmcnt(0)
    s_barrier
    v_mov_b32 v198, 2147516415
    v_mov_b32 v199, 2147516415
    s_lshl_b32 s64, s3, 9
    v_lshl_add_u32 v200, v249, 3, s64
    ds_write_b64 v200, v[198:199]
    v_mov_b32 v202, 0
    v_and_b32 v201, 31, v249
    v_lshlrev_b32 v201, 2, v201
    ds_write_b32 v201, v202 offset:23552
    s_lshl_b32 s68, s3, 5
    v_lshrrev_b32 v195, 1, v249
    v_add_u32 v195, s68, v195
    v_and_b32 v196, 1, v249
    v_lshlrev_b32 v196, 4, v196
    s_lshl_b32 s68, s28, 5
    s_lshl_b32 s69, s28, 12
    s_add_u32 s69, s69, 2097152
    v_lshl_add_u32 v204, v195, 13, v196
    v_add_u32 v204, s68, v204
    v_lshlrev_b32 v205, 4, v195
    v_add_u32 v205, s69, v205
    v_mul_u32_u24 v195, 12544, v195
    v_add_u32 v195, v195, v196
    v_bfe_u32 v197, v250, 8, 15
    v_lshl_add_u32 v195, v197, 5, v195
    v_add_u32 v195, 3145696, v195
    v_cmp_eq_u32 vcc, 0, v197
    s_nop 1
    v_cndmask_b32 v205, v195, v205, vcc
    buffer_load_dwordx4 v[210:213], v204, s[16:19], 0 offen sc1
    buffer_load_dwordx4 v[214:217], v205, s[16:19], 0 offen sc1
    v_and_b32 v195, 1, v249
    v_mov_b32 v200, 4
    v_mov_b32 v193, 6
    v_and_b32 v164, 15, v249
    v_lshlrev_b32 v201, 2, v164
    v_and_b32 v202, 48, v249
    v_xor_b32 v174, 15, v164
    v_lshrrev_b32 v175, 2, v202
    v_xor_b32 v175, 15, v175
    s_lshl_b32 s67, s3, 9
    v_lshrrev_b32 v165, 3, v249
    v_lshl_add_u32 v242, v165, 2, s67
    v_lshrrev_b32 v165, 4, v249
    v_and_b32 v166, 3, v249
    v_lshrrev_b32 v167, 2, v164
    v_lshl_add_u32 v168, v165, 2, v167
    v_lshl_add_u32 v239, v168, 2, s67
    v_lshl_add_u32 v169, v165, 2, v166
    s_lshl_b32 s64, s3, 10
    s_add_u32 s64, s64, 4096
    v_lshl_add_u32 v241, v169, 3, s64
    s_lshl_b32 s65, s3, 8
    s_add_u32 s65, s65, 12288
    v_lshl_add_u32 v240, v165, 3, s65
    v_and_b32 v170, 1, v165
    v_lshlrev_b32 v170, 5, v170
    v_lshl_add_u32 v170, v165, 9, v170
    v_lshl_add_u32 v170, v164, 1, v170
    v_add_u32 v243, s34, v170
    v_xor_b32 v244, 32, v243
    v_and_b32 v163, 1, v167
    v_lshlrev_b32 v163, 1, v163
    v_xor_b32 v163, v163, v165
    v_lshlrev_b32 v163, 4, v163
    v_lshl_add_u32 v163, v164, 7, v163
    v_add_u32 v245, s34, v163
    s_mov_b32 s55, 0
    s_waitcnt vmcnt(0) lgkmcnt(0)
    s_barrier
    s_branch L_pass
L_ovf:
    v_mov_b32 v124, 151040
    s_mul_i32 s38, s28, 12544
    s_add_u32 s38, s38, 3145728
    s_mov_b32 s37, 159236
    s_mov_b64 exec, s[56:57]
    s_cbranch_execz L_ov0
    v_cmp_lt_u32 vcc, 10, v48
    v_lshl_add_u32 v125, v64, 4, s37
    v_lshl_add_u32 v125, v48, 2, v125
    s_andn2_b64 exec, exec, vcc
    ds_write_b32 v125, v72
    s_mov_b64 exec, vcc
    s_cbranch_execz L_ov0
    ds_add_rtn_u32 v125, v124, v229
    v_lshl_or_b32 v126, v64, 23, v72
    s_waitcnt lgkmcnt(0)
    v_lshlrev_b32 v125, 2, v125
    buffer_store_dword v126, v125, s[16:19], s38 offen sc1
    s_waitcnt vmcnt(0)
L_ov0:
    s_mov_b64 exec, s[58:59]
    s_cbranch_execz L_ov1
    v_cmp_lt_u32 vcc, 10, v49
    v_lshl_add_u32 v125, v65, 4, s37
    v_lshl_add_u32 v125, v49, 2, v125
    s_andn2_b64 exec, exec, vcc
    ds_write_b32 v125, v73
    s_mov_b64 exec, vcc
    s_cbranch_execz L_ov1
    ds_add_rtn_u32 v125, v124, v229
    v_lshl_or_b32 v126, v65, 23, v73
    s_waitcnt lgkmcnt(0)
    v_lshlrev_b32 v125, 2, v125
    buffer_store_dword v126, v125, s[16:19], s38 offen sc1
    s_waitcnt vmcnt(0)
L_ov1:
    s_mov_b64 exec, s[60:61]
    s_cbranch_execz L_ov2
    v_cmp_lt_u32 vcc, 10, v50
    v_lshl_add_u32 v125, v66, 4, s37
    v_lshl_add_u32 v125, v50, 2, v125
    s_andn2_b64 exec, exec, vcc
    ds_write_b32 v125, v74
    s_mov_b64 exec, vcc
    s_cbranch_execz L_ov2
    ds_add_rtn_u32 v125, v124, v229
    v_lshl_or_b32 v126, v66, 23, v74
    s_waitcnt lgkmcnt(0)
    v_lshlrev_b32 v125, 2, v125
    buffer_store_dword v126, v125, s[16:19], s38 offen sc1
    s_waitcnt vmcnt(0)
L_ov2:
    s_mov_b64 exec, s[62:63]
    s_cbranch_execz L_ov3
    v_cmp_lt_u32 vcc, 10, v51
    v_lshl_add_u32 v125, v67, 4, s37
    v_lshl_add_u32 v125, v51, 2, v125
    s_andn2_b64 exec, exec, vcc
    ds_write_b32 v125, v75
    s_mov_b64 exec, vcc
    s_cbranch_execz L_ov3
    ds_add_rtn_u32 v125, v124, v229
    v_lshl_or_b32 v126, v67, 23, v75
    s_waitcnt lgkmcnt(0)
    v_lshlrev_b32 v125, 2, v125
    buffer_store_dword v126, v125, s[16:19], s38 offen sc1
    s_waitcnt vmcnt(0)
L_ov3:
    s_mov_b64 exec, s[64:65]
    s_cbranch_execz L_ov4
    v_cmp_lt_u32 vcc, 10, v52
    v_lshl_add_u32 v125, v68, 4, s37
    v_lshl_add_u32 v125, v52, 2, v125
    s_andn2_b64 exec, exec, vcc
    ds_write_b32 v125, v76
    s_mov_b64 exec, vcc
    s_cbranch_execz L_ov4
    ds_add_rtn_u32 v125, v124, v229
    v_lshl_or_b32 v126, v68, 23, v76
    s_waitcnt lgkmcnt(0)
    v_lshlrev_b32 v125, 2, v125
    buffer_store_dword v126, v125, s[16:19], s38 offen sc1
    s_waitcnt vmcnt(0)
L_ov4:
    s_mov_b64 exec, s[66:67]
    s_cbranch_execz L_ov5
    v_cmp_lt_u32 vcc, 10, v53
    v_lshl_add_u32 v125, v69, 4, s37
    v_lshl_add_u32 v125, v53, 2, v125
    s_andn2_b64 exec, exec, vcc
    ds_write_b32 v125, v77
    s_mov_b64 exec, vcc
    s_cbranch_execz L_ov5
    ds_add_rtn_u32 v125, v124, v229
    v_lshl_or_b32 v126, v69, 23, v77
    s_waitcnt lgkmcnt(0)
    v_lshlrev_b32 v125, 2, v125
    buffer_store_dword v126, v125, s[16:19], s38 offen sc1
    s_waitcnt vmcnt(0)
L_ov5:
    s_mov_b64 exec, s[68:69]
    s_cbranch_execz L_ov6
    v_cmp_lt_u32 vcc, 10, v54
    v_lshl_add_u32 v125, v70, 4, s37
    v_lshl_add_u32 v125, v54, 2, v125
    s_andn2_b64 exec, exec, vcc
    ds_write_b32 v125, v78
    s_mov_b64 exec, vcc
    s_cbranch_execz L_ov6
    ds_add_rtn_u32 v125, v124, v229
    v_lshl_or_b32 v126, v70, 23, v78
    s_waitcnt lgkmcnt(0)
    v_lshlrev_b32 v125, 2, v125
    buffer_store_dword v126, v125, s[16:19], s38 offen sc1
    s_waitcnt vmcnt(0)
L_ov6:
    s_mov_b64 exec, -1
    s_branch L_noovf
L_e2pub:
    ds_read_b128 v[44:47], v37
    s_waitcnt lgkmcnt(0)
    v_and_or_b32 v44, v44, s37, v48
    v_and_or_b32 v45, v45, s37, v59
    v_and_or_b32 v46, v46, s37, v60
    v_and_or_b32 v47, v47, s37, v61
    s_mov_b64 exec, s[56:57]
    buffer_store_dwordx4 v[44:47], v36, s[16:19], s39 offen sc1
    s_mov_b64 exec, -1
    s_branch L_staged
L_p1_rare:
    v_bfe_u32 v198, v250, 8, 15
    v_cmp_eq_u32 s[68:69], 0, v198
    v_cmp_eq_u32 vcc, 0, v195
    s_nop 0
    s_and_b64 s[60:61], vcc, s[68:69]
    s_and_b64 s[60:61], s[60:61], s[56:57]
    s_mov_b64 s[58:59], s[68:69]
    s_mov_b32 s68, 0
    s_mov_b64 s[66:67], s[60:61]
L_py_chk:
    s_mov_b64 exec, s[66:67]
    v_xor_b32 v206, s85, v214
    v_xor_b32 v207, s86, v215
    v_xor_b32 v208, s87, v216
    v_xor_b32 v209, s88, v217
    v_or3_b32 v206, v206, v207, v208
    v_or_b32 v206, v206, v209
    v_cmp_le_u32 vcc, 0x800000, v206
    s_nop 0
    s_and_b64 s[66:67], vcc, exec
    s_cbranch_scc0 L_py_ok
    s_add_u32 s68, s68, 1
    s_cmp_ge_u32 s68, 131072
    s_cbranch_scc1 L_py_ok
    s_mov_b64 exec, s[66:67]
    buffer_load_dwordx4 v[214:217], v205, s[16:19], 0 offen sc1
    s_waitcnt vmcnt(0)
    s_branch L_py_chk
L_py_ok:
    s_mov_b64 exec, -1
    s_mov_b64 s[68:69], s[58:59]
    v_cmp_le_i32 vcc, 0, v250
    s_nop 0
    s_and_b64 s[58:59], vcc, s[56:57]
    v_lshlrev_b32 v198, 3, v198
    v_lshl_add_u32 v198, v195, 2, v198
    v_subrev_u32 v198, 8, v198
    v_subrev_u32 v199, 7, v196
    v_med3_i32 v199, v199, 0, 4
    v_bfm_b32 v199, v199, 4
    s_and_b64 exec, s[60:61], s[58:59]
    v_or_b32 v250, v199, v250
    s_mov_b64 exec, -1
    s_andn2_b64 s[58:59], s[58:59], s[68:69]
    v_add_u32 v199, 0, v198
    v_cmp_lt_u32 vcc, v199, v197
    s_nop 0
    s_and_b64 s[60:61], vcc, s[58:59]
    v_lshrrev_b32 v199, 23, v214
    v_cmp_eq_u32 vcc, s28, v199
    s_nop 0
    s_and_b64 exec, vcc, s[60:61]
    v_or_b32 v250, 16, v250
    s_mov_b64 exec, -1
    v_add_u32 v199, 1, v198
    v_cmp_lt_u32 vcc, v199, v197
    s_nop 0
    s_and_b64 s[60:61], vcc, s[58:59]
    v_lshrrev_b32 v199, 23, v215
    v_cmp_eq_u32 vcc, s28, v199
    s_nop 0
    s_and_b64 exec, vcc, s[60:61]
    v_or_b32 v250, 32, v250
    s_mov_b64 exec, -1
    v_add_u32 v199, 2, v198
    v_cmp_lt_u32 vcc, v199, v197
    s_nop 0
    s_and_b64 s[60:61], vcc, s[58:59]
    v_lshrrev_b32 v199, 23, v216
    v_cmp_eq_u32 vcc, s28, v199
    s_nop 0
    s_and_b64 exec, vcc, s[60:61]
    v_or_b32 v250, 64, v250
    s_mov_b64 exec, -1
    v_add_u32 v199, 3, v198
    v_cmp_lt_u32 vcc, v199, v197
    s_nop 0
    s_and_b64 s[60:61], vcc, s[58:59]
    v_lshrrev_b32 v199, 23, v217
    v_cmp_eq_u32 vcc, s28, v199
    s_nop 0
    s_and_b64 exec, vcc, s[60:61]
    v_or_b32 v250, 128, v250
    s_mov_b64 exec, -1
    v_or_b32 v250, 0x80000000, v250
    v_and_b32 v222, 16, v250
    v_lshrrev_b32 v230, 14, v214
    v_mul_u32_u24_sdwa v170, v214, v193 dst_sel:DWORD dst_unused:UNUSED_PAD src0_sel:WORD_0 src1_sel:DWORD
    v_and_b32 v223, 32, v250
    v_lshrrev_b32 v231, 14, v215
    v_mul_u32_u24_sdwa v171, v215, v193 dst_sel:DWORD dst_unused:UNUSED_PAD src0_sel:WORD_0 src1_sel:DWORD
    v_and_b32 v224, 64, v250
    v_lshrrev_b32 v232, 14, v216
    v_mul_u32_u24_sdwa v172, v216, v193 dst_sel:DWORD dst_unused:UNUSED_PAD src0_sel:WORD_0 src1_sel:DWORD
    v_and_b32 v225, 128, v250
    v_lshrrev_b32 v233, 14, v217
    v_mul_u32_u24_sdwa v173, v217, v193 dst_sel:DWORD dst_unused:UNUSED_PAD src0_sel:WORD_0 src1_sel:DWORD
    v_cmp_ne_u32 s[64:65], 0, v222
    v_and_b32 v230, 60, v230
    v_and_b32 v170, -4, v170
    v_cmp_ne_u32 s[66:67], 0, v223
    v_and_b32 v231, 60, v231
    v_and_b32 v171, -4, v171
    v_cmp_ne_u32 s[68:69], 0, v224
    v_and_b32 v232, 60, v232
    v_and_b32 v172, -4, v172
    v_cmp_ne_u32 s[70:71], 0, v225
    v_and_b32 v233, 60, v233
    v_and_b32 v173, -4, v173
    s_mov_b64 exec, s[64:65]
    ds_add_rtn_u32 v222, v230, v200 offset:23552
    buffer_load_dwordx2 v[184:185], v170, s[24:27], 0 offen
    s_mov_b64 exec, s[66:67]
    ds_add_rtn_u32 v223, v231, v200 offset:23552
    buffer_load_dwordx2 v[186:187], v171, s[24:27], 0 offen
    s_mov_b64 exec, s[68:69]
    ds_add_rtn_u32 v224, v232, v200 offset:23552
    buffer_load_dwordx2 v[188:189], v172, s[24:27], 0 offen
    s_mov_b64 exec, s[70:71]
    ds_add_rtn_u32 v225, v233, v200 offset:23552
    buffer_load_dwordx2 v[190:191], v173, s[24:27], 0 offen
    s_mov_b64 exec, -1
    s_branch L_p1_done
L_p2_rare:
    ds_bpermute_b32 v160, v230, v165
    ds_bpermute_b32 v161, v231, v165
    ds_bpermute_b32 v162, v232, v165
    ds_bpermute_b32 v163, v233, v165
    v_lshlrev_b32 v170, 7, v214
    v_and_b32 v214, 0x7fffff, v214
    v_and_or_b32 v214, v170, s70, v214
    v_lshlrev_b32 v171, 7, v215
    v_and_b32 v215, 0x7fffff, v215
    v_and_or_b32 v215, v171, s70, v215
    v_lshlrev_b32 v172, 7, v216
    v_and_b32 v216, 0x7fffff, v216
    v_and_or_b32 v216, v172, s70, v216
    v_lshlrev_b32 v173, 7, v217
    v_and_b32 v217, 0x7fffff, v217
    v_and_or_b32 v217, v173, s70, v217
    v_and_b32 v198, 16, v250
    v_cmp_ne_u32 s[64:65], 0, v198
    v_and_b32 v198, 32, v250
    v_cmp_ne_u32 s[66:67], 0, v198
    v_and_b32 v198, 64, v250
    v_cmp_ne_u32 s[68:69], 0, v198
    v_and_b32 v198, 128, v250
    v_cmp_ne_u32 s[48:49], 0, v198
    s_waitcnt vmcnt(0) lgkmcnt(0)
    s_mov_b64 exec, s[64:65]
    v_add_u32_sdwa v222, v160, v222 dst_sel:DWORD dst_unused:UNUSED_PAD src0_sel:WORD_0 src1_sel:DWORD
    v_lshlrev_b32 v199, 14, v160
    v_and_or_b32 v214, v199, s71, v214
    v_cmp_lt_u32_sdwa vcc, v222, v160 src0_sel:DWORD src1_sel:WORD_1
    s_nop 0
    s_mov_b64 exec, vcc
    ds_write_b32 v222, v214 offset:0
    v_xor_b32 v250, 16, v250
    v_lshlrev_b32 v198, 1, v222
    ds_write_b64 v198, v[184:185] offset:4096
    s_mov_b64 exec, s[66:67]
    v_add_u32_sdwa v223, v161, v223 dst_sel:DWORD dst_unused:UNUSED_PAD src0_sel:WORD_0 src1_sel:DWORD
    v_lshlrev_b32 v199, 14, v161
    v_and_or_b32 v215, v199, s71, v215
    v_cmp_lt_u32_sdwa vcc, v223, v161 src0_sel:DWORD src1_sel:WORD_1
    s_nop 0
    s_mov_b64 exec, vcc
    ds_write_b32 v223, v215 offset:0
    v_xor_b32 v250, 32, v250
    v_lshlrev_b32 v198, 1, v223
    ds_write_b64 v198, v[186:187] offset:4096
    s_mov_b64 exec, s[68:69]
    v_add_u32_sdwa v224, v162, v224 dst_sel:DWORD dst_unused:UNUSED_PAD src0_sel:WORD_0 src1_sel:DWORD
    v_lshlrev_b32 v199, 14, v162
    v_and_or_b32 v216, v199, s71, v216
    v_cmp_lt_u32_sdwa vcc, v224, v162 src0_sel:DWORD src1_sel:WORD_1
    s_nop 0
    s_mov_b64 exec, vcc
    ds_write_b32 v224, v216 offset:0
    v_xor_b32 v250, 64, v250
    v_lshlrev_b32 v198, 1, v224
    ds_write_b64 v198, v[188:189] offset:4096
    s_mov_b64 exec, s[48:49]
    v_add_u32_sdwa v225, v163, v225 dst_sel:DWORD dst_unused:UNUSED_PAD src0_sel:WORD_0 src1_sel:DWORD
    v_lshlrev_b32 v199, 14, v163
    v_and_or_b32 v217, v199, s71, v217
    v_cmp_lt_u32_sdwa vcc, v225, v163 src0_sel:DWORD src1_sel:WORD_1
    s_nop 0
    s_mov_b64 exec, vcc
    ds_write_b32 v225, v217 offset:0
    v_xor_b32 v250, 128, v250
    v_lshlrev_b32 v198, 1, v225
    ds_write_b64 v198, v[190:191] offset:4096
    s_mov_b64 exec, -1
    v_bfe_u32 v198, v250, 8, 15
    v_lshlrev_b32 v198, 3, v198
    v_lshl_add_u32 v198, v195, 2, v198
    v_cmp_lt_u32 vcc, v198, v197
    v_cmp_lt_u32 s[60:61], 11, v196
    s_nop 0
    s_and_b64 s[58:59], vcc, s[60:61]
    v_and_b32 v199, 0xf0, v250
    v_cmp_eq_u32 vcc, 0, v199
    s_nop 0
    s_and_b64 exec, vcc, s[58:59]
    v_add_u32 v250, 0x80000100, v250
    s_mov_b64 exec, -1
    v_cmp_le_i32 vcc, 0, v250
    s_nop 0
    s_and_b64 s[58:59], vcc, s[56:57]
    s_branch L_p2_done
.section .rodata,"a"
.p2align 6
.amdhsa_kernel gather_scatter__molecular_angular_painn__graph_kernel
  .amdhsa_next_free_vgpr 256
  .amdhsa_next_free_sgpr 102
  .amdhsa_accum_offset 256
  .amdhsa_group_segment_fixed_size 0
  .amdhsa_kernarg_size 88
  .amdhsa_user_sgpr_count 2
  .amdhsa_user_sgpr_kernarg_segment_ptr 1
  .amdhsa_system_sgpr_workgroup_id_x 1
  .amdhsa_float_denorm_mode_32 3
.end_amdhsa_kernel
```
